```python
import torch

def _softmax(x, axis=-1):
    return torch.softmax(x, dim=axis)
def _gelu(x):
    return torch.nn.functional.gelu(x, approximate="tanh")
def _silu(x):
    return torch.nn.functional.silu(x)
def _sigmoid(x):
    return torch.sigmoid(x)
def _layernorm(x, axis=-1, eps=1e-5):
    m = x.mean(dim=axis, keepdim=True)
    v = x.var(dim=axis, keepdim=True, unbiased=False)
    return (x - m) / torch.sqrt(v + eps)
def _scatter_add(tgt, idx, src, axis=0):
    return tgt.clone().index_add_(axis, idx, src)
def _segment_sum(src, seg, n):
    out = torch.zeros((n,) + src.shape[1:], dtype=src.dtype)
    return out.index_add_(0, seg, src)
def _pad(x, pw):
    flat = tuple(v for pair in reversed(pw) for v in pair)
    return torch.nn.functional.pad(x, flat)

kernel_name = 'interleave_layers__sliding_block_cached__glu_gated_bilinear__decode'

def setup_inputs():

    _w = (lambda a: (lambda t: t.to(torch.bfloat16) if t.is_floating_point() else t)(torch.as_tensor(a)))
    def _A_setup():
        B, Sq, D = 1, 1, 576
        Hq, Hkv, Sk, Dh = 32, 16, 32768, 128
        assert Hq % Hkv == 0, (Hq, Hkv)
        return {
            "x": _w((lambda *s: torch.randn(*s, dtype=torch.bfloat16) * 0.05)(B, Sq, D)),
            "k_cache": _w((lambda *s: torch.randn(*s, dtype=torch.bfloat16) * 0.8)(B, Hkv, Sk, Dh)),
            "v_cache": _w((lambda *s: torch.randn(*s, dtype=torch.bfloat16) * 0.8)(B, Hkv, Sk, Dh)),
            "wq": _w((lambda *s: torch.randn(*s, dtype=torch.bfloat16) * 0.8)(D, Hq * Dh) * (D ** -0.5)),
            "wo": _w((lambda *s: torch.randn(*s, dtype=torch.bfloat16) * 0.8)(Hq * Dh, D) * ((Hq * Dh) ** -0.5)),
        }
    _A_in = _A_setup()

    def _B_setup():
        B, S, D, F = 1, 1, 576, 4608
        return {
            "x": _w((lambda *s: torch.randn(*s, dtype=torch.bfloat16) * 0.05)(B, S, D)),
            "w_gate": _w((lambda *s: torch.randn(*s, dtype=torch.bfloat16) * 0.2)(D, F) * (D ** -0.5)),
            "w_up": _w((lambda *s: torch.randn(*s, dtype=torch.bfloat16) * 0.2)(D, F) * (D ** -0.5)),
            "w_down": _w((lambda *s: torch.randn(*s, dtype=torch.bfloat16) * 0.2)(F, D) * (F ** -0.5)),
        }
    _B_in = _B_setup()

    return {
        "A_x": _A_in["x"],
        "A_k_cache": _A_in["k_cache"],
        "A_v_cache": _A_in["v_cache"],
        "A_wq": _A_in["wq"],
        "A_wo": _A_in["wo"],
        "B_x": _B_in["x"],
        "B_w_gate": _B_in["w_gate"],
        "B_w_up": _B_in["w_up"],
        "B_w_down": _B_in["w_down"],
    }

def reference(A_x, A_k_cache, A_v_cache, A_wq, A_wo, B_x, B_w_gate, B_w_up, B_w_down):
    def _A_ref(x, k_cache, v_cache, wq, wo):
        B, Sq, D = x.shape
        Hq, Dh = 32, 128
        Hkv, Sk = k_cache.shape[1], k_cache.shape[2]
        W = min(4096, max(256, Sk // 4))
        rep = Hq // Hkv
        q = (lambda x, *d: x.permute(*d))((x @ wq).reshape(B, Sq, Hq, Dh), 0, 2, 1, 3)
        k = (lambda x, n, axis: torch.repeat_interleave(x, n, dim=axis))(k_cache[:, :, Sk - W:, :], rep, axis=1)
        v = (lambda x, n, axis: torch.repeat_interleave(x, n, dim=axis))(v_cache[:, :, Sk - W:, :], rep, axis=1)
        scores = torch.einsum("bhqd,bhkd->bhqk", q, k) * (Dh ** -0.5)
        p = _softmax(scores, axis=-1)
        o = torch.einsum("bhqk,bhkd->bhqd", p, v)
        return (lambda x, *d: x.permute(*d))(o, 0, 2, 1, 3).reshape(B, Sq, Hq * Dh) @ wo

    def _B_ref(x, w_gate, w_up, w_down):
        g = torch.einsum("bsd,df->bsf", x, w_gate)
        u = torch.einsum("bsd,df->bsf", x, w_up)
        h = g * u
        return torch.einsum("bsf,fd->bsd", h, w_down)

    x = A_x
    x = x + _A_ref(_layernorm(x, axis=-1), A_k_cache, A_v_cache, A_wq, A_wo)
    x = x + _B_ref(_layernorm(x, axis=-1), B_w_gate, B_w_up, B_w_down)
    x = x + _A_ref(_layernorm(x, axis=-1), A_k_cache, A_v_cache, A_wq, A_wo)
    x = x + _B_ref(_layernorm(x, axis=-1), B_w_gate, B_w_up, B_w_down)
    return x
```

```asm
; @launch grid=(256,1,1) block=(576,1,1) lds=163840
.amdgcn_target "amdgcn-amd-amdhsa--gfx950"
.text
.globl interleave_layers__sliding_block_cached__glu_gated_bilinear__decode_kernel
.p2align 8
.type interleave_layers__sliding_block_cached__glu_gated_bilinear__decode_kernel,@function
interleave_layers__sliding_block_cached__glu_gated_bilinear__decode_kernel:
    s_cmp_ge_u32 s2, 256
    s_cbranch_scc1 EXIT0
    s_load_dwordx16 s[16:31], s[0:1], 0
    s_load_dwordx8 s[32:39], s[0:1], 64
    v_lshrrev_b32 v2, 6, v0
    v_and_b32 v1, 63, v0
    s_and_b32 s49, s2, 7
    s_lshr_b32 s50, s2, 3
    v_readfirstlane_b32 s48, v2
    s_lshr_b32 s53, s50, 4
    s_mul_i32 s51, s50, 43
    s_lshr_b32 s51, s51, 7
    s_mul_i32 s52, s51, 3
    s_sub_u32 s52, s50, s52
    s_mov_b32 s56, 0x80000
    s_mov_b32 s54, 0
    v_mov_b32 v147, 155648
    v_lshrrev_b32 v2, 4, v1
    v_and_b32 v3, 15, v1
    s_cmp_eq_u32 s48, 8
    s_cbranch_scc0 COMPUTE
    v_xor_b32 v10, v3, v2
    v_lshlrev_b32 v9, 8, v2
    v_lshl_add_u32 v4, v10, 4, v9
    v_xor_b32 v5, 64, v4
    v_xor_b32 v6, 0x80, v4
    v_xor_b32 v7, 0xc0, v4
    s_lshl_b32 s67, s49, 1
    s_add_u32 s67, s67, s53
    s_lshl_b32 s67, s67, 23
    s_and_b32 s68, s50, 15
    s_lshl_b32 s68, s68, 16
    s_add_u32 s67, s67, s68
    s_add_u32 s71, s67, 7340032
    s_mul_i32 s61, s2, 0x9e3779b1
    s_lshr_b32 s61, s61, 28
    s_lshl_b32 s61, s61, 12
    s_add_u32 s60, s71, s61
    s_mov_b32 m0, 24576
    v_mov_b32 v8, -20
    s_waitcnt lgkmcnt(0)
    s_mov_b32 s44, s18
    s_mov_b32 s45, s19
    s_mov_b32 s46, 134217728
    s_mov_b32 s47, 0x20000
    s_mov_b32 s62, 5
LK1:
    buffer_load_dwordx4 v4, s[44:47], s60 offen offset:0 nt lds
    buffer_load_dwordx4 v5, s[44:47], s60 offen offset:1024 nt lds
    buffer_load_dwordx4 v6, s[44:47], s60 offen offset:2048 nt lds
    buffer_load_dwordx4 v7, s[44:47], s60 offen offset:3072 nt lds
    s_add_u32 s61, s61, 0x1000
    s_and_b32 s61, s61, 0xffff
    s_add_u32 s60, s71, s61
    s_add_u32 m0, m0, 0x1000
    v_add_u32 v8, 4, v8
    s_sub_u32 s62, s62, 1
    s_cmp_lg_u32 s62, 0
    s_cbranch_scc1 LK1
    s_barrier
    s_mov_b32 s63, 0
    s_mov_b32 s64, 0
    s_mov_b32 s62, 11
KVS:
    ds_read_b32 v11, v147 offset:44
    s_waitcnt vmcnt(20)
    s_mov_b64 exec, 1
    ds_max_i32 v147, v8 offset:28
    s_mov_b64 exec, -1
    buffer_load_dwordx4 v4, s[44:47], s60 offen offset:0 nt lds
    s_waitcnt vmcnt(20)
    buffer_load_dwordx4 v5, s[44:47], s60 offen offset:1024 nt lds
    s_waitcnt vmcnt(20)
    buffer_load_dwordx4 v6, s[44:47], s60 offen offset:2048 nt lds
    s_waitcnt vmcnt(20)
    buffer_load_dwordx4 v7, s[44:47], s60 offen offset:3072 nt lds
    s_add_u32 s61, s61, 0x1000
    s_and_b32 s61, s61, 0xffff
    s_add_u32 s60, s71, s61
    s_add_u32 m0, m0, 0x1000
    v_add_u32 v8, 4, v8
    s_sub_u32 s62, s62, 1
    s_cmp_lg_u32 s62, 0
    s_cbranch_scc0 KVE
    s_waitcnt lgkmcnt(0)
    v_cmp_gt_u32 vcc, 4, v11
    s_cbranch_vccnz KVS
    s_mov_b32 s63, 1
    v_add_u32 v8, -20, v8
KVD:
    s_waitcnt vmcnt(40)
    s_mov_b64 exec, 1
    ds_max_i32 v147, v8 offset:28
    s_mov_b64 exec, -1
    buffer_load_dwordx4 v4, s[44:47], s60 offen offset:0 nt lds
    s_waitcnt vmcnt(40)
    buffer_load_dwordx4 v5, s[44:47], s60 offen offset:1024 nt lds
    s_waitcnt vmcnt(40)
    buffer_load_dwordx4 v6, s[44:47], s60 offen offset:2048 nt lds
    s_waitcnt vmcnt(40)
    buffer_load_dwordx4 v7, s[44:47], s60 offen offset:3072 nt lds
    s_add_u32 s61, s61, 0x1000
    s_and_b32 s61, s61, 0xffff
    s_add_u32 s60, s71, s61
    s_add_u32 m0, m0, 0x1000
    v_add_u32 v8, 4, v8
    s_sub_u32 s62, s62, 1
    s_cmp_lg_u32 s62, 0
    s_cbranch_scc1 KVD
KVE:
    s_cmp_eq_u32 s64, 0
    s_cbranch_scc0 KVX
    s_mov_b32 s64, 1
    v_lshlrev_b32 v10, 1, v2
    v_xor_b32 v10, v3, v10
    v_lshl_add_u32 v4, v10, 4, v9
    v_mov_b32 v5, v4
    v_xor_b32 v6, 0x80, v4
    v_xor_b32 v7, 0x80, v4
    s_mov_b32 m0, 90112
    s_mov_b32 s44, s20
    s_mov_b32 s45, s21
    s_mov_b32 s62, 16
    s_cmp_eq_u32 s63, 0
    s_cbranch_scc1 KVS
    s_branch KVD
KVX:
    s_cmp_eq_u32 s63, 0
    s_cbranch_scc0 KVY
    v_add_u32 v8, -20, v8
KVY:
    s_cmp_ge_u32 s50, 27
    s_cbranch_scc1 LDRAINA
    v_add_u32 v8, 24, v8
    v_lshrrev_b32 v12, 3, v1
    v_and_b32 v13, 7, v1
    v_and_b32 v10, 1, v2
    v_lshlrev_b32 v10, 1, v10
    v_xor_b32 v13, v13, v10
    v_lshlrev_b32 v13, 4, v13
    v_xor_b32 v14, 64, v13
    v_mul_u32_u24 v9, 1152, v12
    v_add_u32 v4, v13, v9
    v_add_u32 v5, v14, v9
    s_mul_i32 s67, s52, 160
    s_cmp_lg_u32 s52, 0
    s_cselect_b32 s68, 32, 0
    s_cselect_b32 s69, 5, 6
    s_add_u32 s67, s67, s68
    s_lshl_b32 s68, s49, 9
    s_add_u32 s67, s67, s68
    s_mul_i32 s67, s67, 1152
    s_lshl_b32 s70, s51, 7
    s_add_u32 s60, s67, s70
    s_mov_b32 m0, 24576
    s_mov_b32 s44, s24
    s_mov_b32 s45, s25
    s_mov_b32 s46, 4718592
    s_mov_b32 s47, 0x20000
WC_1:
    ds_read_b32 v11, v147 offset:32
    s_sub_u32 s56, s56, 1
    s_cbranch_scc1 EXIT
    s_waitcnt lgkmcnt(0)
    v_cmp_le_i32 vcc, 4, v11
    s_cbranch_vccz WC_1
    s_mov_b32 s62, s69
LO1:
    s_waitcnt vmcnt(16)
    s_mov_b64 exec, 1
    ds_max_i32 v147, v8 offset:28
    s_mov_b64 exec, -1
    buffer_load_dwordx4 v4, s[44:47], s60 offen nt lds
    s_add_u32 m0, m0, 0x400
    s_add_u32 s60, s60, 9216
    s_waitcnt vmcnt(16)
    buffer_load_dwordx4 v5, s[44:47], s60 offen nt lds
    s_add_u32 m0, m0, 0x400
    s_add_u32 s60, s60, 9216
    s_waitcnt vmcnt(16)
    buffer_load_dwordx4 v4, s[44:47], s60 offen nt lds
    s_add_u32 m0, m0, 0x400
    s_add_u32 s60, s60, 9216
    s_waitcnt vmcnt(16)
    buffer_load_dwordx4 v5, s[44:47], s60 offen nt lds
    s_add_u32 m0, m0, 0x400
    s_add_u32 s60, s60, 9216
    v_add_u32 v8, 4, v8
    s_sub_u32 s62, s62, 1
    s_cmp_lg_u32 s62, 0
    s_cbranch_scc1 LO1
    v_mul_u32_u24 v9, 9216, v12
    v_add_u32 v4, v13, v9
    v_add_u32 v5, v14, v9
    s_mul_i32 s67, s52, 1769472
    s_mul_i32 s68, s49, 1152
    s_add_u32 s67, s67, s68
    s_add_u32 s71, s67, s70
    s_mov_b32 s60, s71
    s_mov_b32 m0, 49152
    s_mov_b32 s44, s28
    s_mov_b32 s45, s29
    s_mov_b32 s46, 5308416
    s_mov_b32 s47, 0x20000
    s_mov_b32 s62, 6
LG1:
    s_waitcnt vmcnt(16)
    s_mov_b64 exec, 1
    ds_max_i32 v147, v8 offset:28
    s_mov_b64 exec, -1
    buffer_load_dwordx4 v4, s[44:47], s60 offen nt lds
    s_add_u32 m0, m0, 0x400
    s_add_u32 s60, s60, 73728
    s_waitcnt vmcnt(16)
    buffer_load_dwordx4 v5, s[44:47], s60 offen nt lds
    s_add_u32 m0, m0, 0x400
    s_add_u32 s60, s60, 73728
    s_waitcnt vmcnt(16)
    buffer_load_dwordx4 v4, s[44:47], s60 offen nt lds
    s_add_u32 m0, m0, 0x400
    s_add_u32 s60, s60, 73728
    s_waitcnt vmcnt(16)
    buffer_load_dwordx4 v5, s[44:47], s60 offen nt lds
    s_add_u32 m0, m0, 0x400
    s_add_u32 s60, s60, 73728
    v_add_u32 v8, 4, v8
    s_sub_u32 s62, s62, 1
    s_cmp_lg_u32 s62, 0
    s_cbranch_scc1 LG1
    s_mov_b32 s60, s71
    s_mov_b32 m0, 90112
    s_mov_b32 s44, s30
    s_mov_b32 s45, s31
WC_2:
    ds_read_b32 v11, v147 offset:36
    s_sub_u32 s56, s56, 1
    s_cbranch_scc1 EXIT
    s_waitcnt lgkmcnt(0)
    v_cmp_le_i32 vcc, 4, v11
    s_cbranch_vccz WC_2
    s_mov_b32 s62, 6
LU1:
    s_waitcnt vmcnt(16)
    s_mov_b64 exec, 1
    ds_max_i32 v147, v8 offset:28
    s_mov_b64 exec, -1
    buffer_load_dwordx4 v4, s[44:47], s60 offen nt lds
    s_add_u32 m0, m0, 0x400
    s_add_u32 s60, s60, 73728
    s_waitcnt vmcnt(16)
    buffer_load_dwordx4 v5, s[44:47], s60 offen nt lds
    s_add_u32 m0, m0, 0x400
    s_add_u32 s60, s60, 73728
    s_waitcnt vmcnt(16)
    buffer_load_dwordx4 v4, s[44:47], s60 offen nt lds
    s_add_u32 m0, m0, 0x400
    s_add_u32 s60, s60, 73728
    s_waitcnt vmcnt(16)
    buffer_load_dwordx4 v5, s[44:47], s60 offen nt lds
    s_add_u32 m0, m0, 0x400
    s_add_u32 s60, s60, 73728
    v_add_u32 v8, 4, v8
    s_sub_u32 s62, s62, 1
    s_cmp_lg_u32 s62, 0
    s_cbranch_scc1 LU1
    v_mul_u32_u24 v9, 1152, v12
    v_add_u32 v4, v13, v9
    v_add_u32 v5, v14, v9
    s_mul_i32 s67, s49, 576
    s_mul_i32 s68, s52, 192
    s_add_u32 s67, s67, s68
    s_mul_i32 s67, s67, 1152
    s_add_u32 s60, s67, s70
    s_mov_b32 m0, 114688
    s_mov_b32 s44, s32
    s_mov_b32 s45, s33
    s_mov_b32 s46, 5308416
    s_mov_b32 s47, 0x20000
    s_mov_b32 s62, 6
LD1:
    s_waitcnt vmcnt(16)
    s_mov_b64 exec, 1
    ds_max_i32 v147, v8 offset:28
    s_mov_b64 exec, -1
    buffer_load_dwordx4 v4, s[44:47], s60 offen nt lds
    s_add_u32 m0, m0, 0x400
    s_add_u32 s60, s60, 9216
    s_waitcnt vmcnt(16)
    buffer_load_dwordx4 v5, s[44:47], s60 offen nt lds
    s_add_u32 m0, m0, 0x400
    s_add_u32 s60, s60, 9216
    s_waitcnt vmcnt(16)
    buffer_load_dwordx4 v4, s[44:47], s60 offen nt lds
    s_add_u32 m0, m0, 0x400
    s_add_u32 s60, s60, 9216
    s_waitcnt vmcnt(16)
    buffer_load_dwordx4 v5, s[44:47], s60 offen nt lds
    s_add_u32 m0, m0, 0x400
    s_add_u32 s60, s60, 9216
    v_add_u32 v8, 4, v8
    s_sub_u32 s62, s62, 1
    s_cmp_lg_u32 s62, 0
    s_cbranch_scc1 LD1
    s_branch LDRAIN
LDRAINA:
    v_add_u32 v8, 24, v8
LDRAIN:
    s_mov_b64 exec, 1
    s_waitcnt vmcnt(16)
    ds_max_i32 v147, v8 offset:28
    v_add_u32 v8, 4, v8
    s_waitcnt vmcnt(12)
    ds_max_i32 v147, v8 offset:28
    v_add_u32 v8, 4, v8
    s_waitcnt vmcnt(8)
    ds_max_i32 v147, v8 offset:28
    v_add_u32 v8, 4, v8
    s_waitcnt vmcnt(4)
    ds_max_i32 v147, v8 offset:28
    v_add_u32 v8, 4, v8
    s_waitcnt vmcnt(0)
    ds_max_i32 v147, v8 offset:28
    v_add_u32 v8, 4, v8
    s_branch EXIT
COMPUTE:
    v_mov_b32 v162, 1
    s_mul_i32 s57, s49, 120832
    v_mov_b64 v[120:121], -1
    v_mov_b64 v[122:123], -1
    v_lshlrev_b32 v124, 4, v1
    v_lshlrev_b32 v125, 3, v1
    v_lshlrev_b32 v126, 4, v3
    v_and_b32 v127, 1, v2
    v_mul_u32_u24 v127, 107520, v127
    v_add_u32 v126, v126, v127
    v_lshrrev_b32 v127, 5, v1
    v_lshl_add_u32 v126, v127, 8, v126
    s_mul_i32 s67, s50, 384
    s_add_u32 s67, s67, s57
    s_lshl_b32 s68, s50, 7
    s_add_u32 s68, s68, s57
    s_add_u32 s74, s68, 116736
    s_mul_i32 s68, s50, 3072
    s_add_u32 s68, s68, s57
    s_add_u32 s71, s68, 9216
    s_lshl_b32 s68, s2, 9
    s_add_u32 s68, s68, 966656
    s_waitcnt lgkmcnt(0)
    s_mov_b32 s40, s38
    s_mov_b32 s41, s39
    s_mov_b32 s42, 1097728
    s_mov_b32 s43, 0x20000
    s_cmp_eq_u32 s48, 6
    s_cbranch_scc0 NOCLEAN2
    s_mov_b64 exec, 1
    buffer_store_dword v120, off, s[40:43], s74 sc1
    s_mov_b64 exec, -1
    s_cmp_ge_u32 s50, 24
    s_cbranch_scc1 NOSELF
    s_mov_b32 exec_hi, 1
    buffer_store_dwordx4 v[120:123], v126, s[40:43], s67 offen sc1
    s_mov_b32 exec_hi, -1
NOSELF:
    buffer_store_dwordx4 v[120:123], v124, s[40:43], s71 offen sc1
    buffer_store_dwordx4 v[120:123], v124, s[40:43], s71 offen offset:1024 sc1
    buffer_store_dwordx4 v[120:123], v124, s[40:43], s71 offen offset:2048 sc1
    buffer_store_dwordx2 v[120:121], v125, s[40:43], s68 offen sc1
NOCLEAN2:
    s_cmp_ge_u32 s50, 24
    s_cbranch_scc1 NOQDMA
    s_cmp_ge_u32 s48, 6
    s_cbranch_scc1 NOQDMA
    v_lshrrev_b32 v104, 3, v1
    v_lshlrev_b32 v104, 13, v104
    v_and_b32 v105, 7, v1
    v_and_b32 v106, 1, v2
    v_lshlrev_b32 v106, 1, v106
    v_xor_b32 v105, v105, v106
    v_lshl_add_u32 v106, v105, 4, v104
    v_xor_b32 v107, 64, v106
    s_mul_i32 s67, s52, 1572864
    s_lshl_b32 s68, s49, 10
    s_add_u32 s67, s67, s68
    s_lshl_b32 s68, s51, 7
    s_add_u32 s67, s67, s68
    s_lshl_b32 s68, s48, 18
    s_add_u32 s67, s67, s68
    s_lshl_b32 m0, s48, 12
    s_mov_b32 s44, s22
    s_mov_b32 s45, s23
    s_mov_b32 s46, 4718592
    s_mov_b32 s47, 0x20000
    buffer_load_dwordx4 v106, s[44:47], s67 offen nt lds
    s_add_u32 m0, m0, 0x400
    s_add_u32 s67, s67, 65536
    buffer_load_dwordx4 v107, s[44:47], s67 offen nt lds
    s_add_u32 m0, m0, 0x400
    s_add_u32 s67, s67, 65536
    buffer_load_dwordx4 v106, s[44:47], s67 offen nt lds
    s_add_u32 m0, m0, 0x400
    s_add_u32 s67, s67, 65536
    buffer_load_dwordx4 v107, s[44:47], s67 offen nt lds
NOQDMA:
    v_and_b32 v108, 7, v1
    s_mul_i32 s67, s52, 384
    s_lshl_b32 s68, s48, 7
    s_add_u32 s70, s67, s68
    v_lshlrev_b32 v104, 2, v2
    v_lshl_add_u32 v104, v108, 4, v104
    v_add_u32 v161, s70, v104
    s_mov_b32 s44, s16
    s_mov_b32 s45, s17
    s_mov_b32 s46, 1152
    s_mov_b32 s47, 0x20000
    s_cmp_lt_u32 s48, 3
    s_cbranch_scc0 NOX0L
    buffer_load_dword v134, v161, s[44:47], 0 offen
NOX0L:
    v_lshl_add_u32 v164, v1, 3, v147
    s_cmp_eq_u32 s48, 0
    s_cbranch_scc0 NOINIT
    v_mov_b32 v112, 0x3f803f80
    v_mov_b32 v113, 0x3f803f80
    v_mov_b64 v[114:115], 0
    v_mov_b64 v[116:117], -1
    ds_write_b64 v164, v[112:113] offset:1280
    ds_write_b64 v164, v[116:117] offset:4608
    s_mov_b64 exec, 0xffff
    ds_write_b64 v164, v[114:115]
    ds_write_b64 v164, v[114:115] offset:768
    s_mov_b64 exec, -1
NOINIT:
    s_mov_b32 s59, 0x00003f80
    s_mov_b32 s60, 0x3f800000
    s_mov_b32 s61, 0x3f803f80
    v_mov_b32 v163, 0x3ae38e39
    s_mov_b32 s63, 0x3e0293ee
    s_mov_b64 s[76:77], 0xffff
    s_mov_b32 s78, 0xffff0000
    s_mov_b32 s79, 0
    s_mov_b32 s80, 0
    s_mov_b32 s81, 0xffff
    s_mov_b32 s82, 0
    s_mov_b32 s83, 0xffff0000
    s_mov_b32 s84, -1
    s_mov_b32 s85, 0
    s_cmp_lg_u32 s52, 0
    s_cselect_b32 s62, 20, 24
    s_cselect_b32 s67, 2, 7
    s_cmp_eq_u32 s48, s67
    s_cselect_b32 s8, 0x000f000f, -1
    s_and_b32 s8, s8, 0x00ff00ff
    s_mov_b32 s9, s8
    s_mov_b32 s58, 966656
    s_add_u32 s65, s57, 107520
    s_add_u32 s66, s57, 60672
    s_mov_b32 s55, 1
    v_lshrrev_b32 v109, 2, v3
    v_and_b32 v110, 3, v3
    v_lshl_add_u32 v111, v2, 3, v109
    v_lshrrev_b32 v104, 1, v109
    v_and_b32 v105, 1, v2
    v_lshl_or_b32 v104, v105, 1, v104
    s_and_b32 s67, s48, 3
    v_xor_b32 v104, s67, v104
    v_lshlrev_b32 v104, 5, v104
    v_lshl_add_u32 v104, v111, 7, v104
    v_lshl_add_u32 v142, v110, 3, v104
    s_cmp_lt_u32 s48, 4
    s_cselect_b32 s68, 0, 40960
    s_add_u32 s68, s68, 49152
    v_add_u32 v143, s68, v142
    v_bfe_u32 v104, v3, 1, 1
    v_mul_u32_u24 v106, 0xaaaa, v104
    v_add_u32 v141, 0x4444, v106
    v_lshlrev_b32 v106, 6, v104
    v_lshl_add_u32 v106, v2, 4, v106
    v_add_u32 v106, 155648, v106
    v_cmp_eq_u32 vcc, 1, v109
    v_add_u32 v107, 1152, v106
    s_nop 0
    v_cndmask_b32 v144, v106, v107, vcc
    v_and_b32 v107, 1, v3
    v_lshl_add_u32 v106, v107, 8, v106
    v_add_u32 v145, 1792, v106
    v_lshlrev_b32 v146, 4, v1
    s_cmp_lt_u32 s48, 4
    s_cbranch_scc1 SXR
    v_lshlrev_b32 v106, 1, v104
    s_lshl_b32 s68, s67, 2
    v_lshl_add_u32 v106, v2, 4, v106
    v_add_u32 v106, s68, v106
    v_lshlrev_b32 v106, 4, v106
    v_lshrrev_b32 v112, 3, v3
    v_lshl_add_u32 v106, v112, 10, v106
    v_and_b32 v112, 1, v109
    v_lshl_add_u32 v112, v112, 1, v107
    v_lshl_add_u32 v146, v112, 2, v106
SXR:
    v_add_u32 v146, 158208, v146
    v_cmp_eq_u32 vcc, 1, v2
    s_lshl_b32 s67, s67, 6
    s_mul_i32 s68, s50, 384
    s_add_u32 s72, s68, 256
    s_add_u32 s68, s68, s67
    v_lshl_add_u32 v106, v3, 2, s68
    v_add_u32 v112, 107520, v106
    v_cndmask_b32 v148, v106, v112, vcc
    s_mul_i32 s68, s50, 640
    s_add_u32 s68, s68, 26112
    s_add_u32 s73, s68, 512
    s_add_u32 s68, s68, s67
    s_cmp_lt_u32 s48, 4
    s_cselect_b32 s69, 0, 256
    s_add_u32 s68, s68, s69
    v_lshl_add_u32 v106, v3, 2, s68
    v_add_u32 v112, 60672, v106
    v_cndmask_b32 v149, v106, v112, vcc
    s_add_u32 s72, s72, s57
    s_add_u32 s73, s73, s57
    v_lshrrev_b32 v106, 1, v2
    v_lshlrev_b32 v106, 2, v106
    v_lshl_add_u32 v153, v105, 3, v106
    s_lshr_b32 s67, s67, 1
    s_add_u32 s67, s67, 160256
    v_lshl_add_u32 v150, v3, 1, s67
    s_cmp_eq_u32 s48, 7
    s_cbranch_scc0 NOPY
    s_mul_i32 s68, s49, 3
    s_add_u32 s68, s68, s52
    s_mul_i32 s68, s68, 1152
    s_lshl_b32 s69, s51, 7
    s_add_u32 s68, s68, s69
    v_lshl_add_u32 v150, v1, 3, s68
NOPY:
    v_lshrrev_b32 v113, 5, v1
    v_and_b32 v114, 31, v1
    s_lshl_b32 s67, s50, 9
    s_lshl_b32 s68, s48, 6
    s_add_u32 s67, s67, s68
    s_add_u32 s67, s67, 9216
    v_lshl_add_u32 v106, v113, 8, s67
    v_lshl_add_u32 v151, v114, 1, v106
    s_lshl_b32 s67, s50, 4
    s_add_u32 s67, s67, 25600
    v_lshl_add_u32 v152, v113, 3, s67
    v_lshlrev_b32 v106, 3, v1
    v_min_u32 v106, 0x100, v106
    s_lshl_b32 s67, s53, 2
    s_add_u32 s67, s67, s48
    s_mul_i32 s67, s67, 1152
    v_add_u32 v154, s67, v106
    v_lshlrev_b32 v106, 4, v1
    v_min_u32 v106, 0x200, v106
    s_mul_i32 s67, s52, 3
    s_add_u32 s67, s67, s48
    s_mul_i32 s67, s67, 1920
    s_add_u32 s67, s67, 26112
    v_add_u32 v158, s67, v106
    s_lshl_b32 s67, s48, 7
    s_add_u32 s67, s67, 155648
    v_lshrrev_b32 v106, 1, v2
    v_lshl_add_u32 v106, v108, 1, v106
    v_lshlrev_b32 v106, 2, v106
    v_lshl_add_u32 v106, v105, 6, v106
    v_add_u32 v159, s67, v106
    s_add_u32 s68, s67, 896
    v_lshl_add_u32 v160, v3, 2, s68
    s_cmp_lt_u32 s48, 4
    s_cbranch_scc0 NOQW0
    v_lshrrev_b32 v106, 1, v114
    v_lshlrev_b32 v106, 2, v106
    v_lshl_add_u32 v106, v107, 6, v106
    s_add_u32 s68, s67, 1792
    v_add_u32 v145, s68, v106
NOQW0:
    s_mul_i32 s67, s52, 160
    s_cmp_lg_u32 s52, 0
    s_cselect_b32 s68, 32, 0
    s_add_u32 s67, s67, s68
    s_lshl_b32 s68, s48, 6
    v_lshl_add_u32 v106, v108, 3, s68
    s_lshl_b32 s68, s62, 3
    s_sub_u32 s68, s68, 8
    v_min_u32 v106, s68, v106
    v_add_u32 v106, s67, v106
    v_lshrrev_b32 v112, 8, v106
    v_lshrrev_b32 v115, 3, v1
    v_lshlrev_b32 v116, 1, v115
    v_lshl_add_u32 v112, v112, 4, v116
    v_and_b32 v116, 0xff, v106
    v_lshlrev_b32 v116, 1, v116
    v_lshl_add_u32 v116, v112, 9, v116
    v_add_u32 v155, 9216, v116
    v_bfe_u32 v116, v106, 7, 1
    v_lshlrev_b32 v116, 3, v116
    v_lshl_add_u32 v116, v112, 4, v116
    v_add_u32 v156, 25600, v116
    v_mul_u32_u24 v106, 3456, v115
    v_lshl_add_u32 v106, v108, 4, v106
    v_add_u32 v157, s70, v106
    s_and_b32 s67, s48, 3
    s_cmp_lt_u32 s48, 4
    s_cbranch_scc1 AKV
    v_xor_b32 v106, v2, v3
    v_lshlrev_b32 v106, 4, v106
    v_lshl_add_u32 v106, v3, 8, v106
    s_lshl_b32 s67, s67, 14
    s_add_u32 s67, s67, 24576
    v_add_u32 v165, s67, v106
    s_branch AKV2
AKV:
    v_lshl_or_b32 v106, v105, 2, v109
    s_lshl_b32 s67, s67, 1
    v_xor_b32 v106, s67, v106
    v_lshlrev_b32 v106, 5, v106
    v_lshl_add_u32 v106, v111, 8, v106
    v_lshl_add_u32 v106, v110, 3, v106
    v_add_u32 v165, 90112, v106
AKV2:
    s_waitcnt lgkmcnt(0)
    s_barrier
    s_mov_b32 s44, s36
    s_mov_b32 s45, s37
    s_mov_b32 s46, 256
    s_mov_b32 s47, 0x20000
    s_cmp_eq_u32 s48, 6
    s_cbranch_scc0 NOFLAG
    s_getreg_b32 s67, hwreg(HW_REG_XCC_ID, 0, 4)
    s_mul_i32 s68, s67, s67
    s_lshl_b32 s68, s68, 8
    s_add_u32 s67, s67, s68
    s_lshl_b32 s67, s67, 8
    s_add_u32 s64, s67, 1
    s_mov_b32 s6, s64
    s_lshl_b32 s67, s49, 5
    s_add_u32 s4, s36, s67
    s_addc_u32 s5, s37, 0
    s_waitcnt vmcnt(0)
    s_atomic_add s6, s[4:5], 0 glc
    s_mov_b64 exec, 1
    ds_add_u32 v147, v162 offset:0
    s_mov_b64 exec, -1
    s_mov_b64 exec, 1
    ds_add_u32 v147, v162 offset:4
    s_mov_b64 exec, -1
    buffer_load_dwordx4 v[68:71], v124, s[40:43], s71 offen offset:0 sc1
    buffer_load_dwordx4 v[72:75], v124, s[40:43], s71 offen offset:1024 sc1
    buffer_load_dwordx4 v[76:79], v124, s[40:43], s71 offen offset:2048 sc1
    s_waitcnt lgkmcnt(0)
    s_and_b32 s67, s6, 31
    s_cmp_eq_u32 s67, 31
    s_cbranch_scc0 NOREL
    s_add_u32 s67, s6, s64
    s_lshl_b32 s68, s64, 5
    s_cmp_eq_u32 s67, s68
    s_cselect_b32 s6, 2, 1
    s_add_u32 s67, s57, 116736
    s_add_u32 s4, s38, s67
    s_addc_u32 s5, s39, 0
    s_atomic_umin s6, s[4:5], 0
    s_atomic_umin s6, s[4:5], 128
    s_atomic_umin s6, s[4:5], 256
    s_atomic_umin s6, s[4:5], 384
    s_atomic_umin s6, s[4:5], 512
    s_atomic_umin s6, s[4:5], 640
    s_atomic_umin s6, s[4:5], 768
    s_atomic_umin s6, s[4:5], 896
    s_atomic_umin s6, s[4:5], 1024
    s_atomic_umin s6, s[4:5], 1152
    s_atomic_umin s6, s[4:5], 1280
    s_atomic_umin s6, s[4:5], 1408
    s_atomic_umin s6, s[4:5], 1536
    s_atomic_umin s6, s[4:5], 1664
    s_atomic_umin s6, s[4:5], 1792
    s_atomic_umin s6, s[4:5], 1920
    s_atomic_umin s6, s[4:5], 2048
    s_atomic_umin s6, s[4:5], 2176
    s_atomic_umin s6, s[4:5], 2304
    s_atomic_umin s6, s[4:5], 2432
    s_atomic_umin s6, s[4:5], 2560
    s_atomic_umin s6, s[4:5], 2688
    s_atomic_umin s6, s[4:5], 2816
    s_atomic_umin s6, s[4:5], 2944
    s_atomic_umin s6, s[4:5], 3072
    s_atomic_umin s6, s[4:5], 3200
    s_atomic_umin s6, s[4:5], 3328
    s_atomic_umin s6, s[4:5], 3456
    s_atomic_umin s6, s[4:5], 3584
    s_atomic_umin s6, s[4:5], 3712
    s_atomic_umin s6, s[4:5], 3840
    s_atomic_umin s6, s[4:5], 3968
    s_waitcnt lgkmcnt(0)
NOREL:
    s_add_u32 s4, s38, s74
    s_addc_u32 s5, s39, 0
GRP:
    s_sleep 4
    s_load_dword s6, s[4:5], 0 glc
    s_sub_u32 s56, s56, 1
    s_cbranch_scc1 EXIT
    s_waitcnt lgkmcnt(0)
    s_cmp_eq_u32 s6, -1
    s_cbranch_scc1 GRP
    v_mov_b32 v124, s6
    s_mov_b64 exec, 1
    ds_write_b32 v147, v124 offset:20
    s_mov_b64 exec, -1
    s_waitcnt vmcnt(0)
    s_branch QDONE
NOFLAG:
    s_waitcnt vmcnt(0)
    s_mov_b64 exec, 1
    ds_add_u32 v147, v162 offset:0
    s_mov_b64 exec, -1
    s_cmp_lt_u32 s48, 3
    s_cbranch_scc0 NOX0
    ds_write_b32 v159, v134 offset:128
    v_and_b32 v135, 0xffff0000, v134
    v_lshlrev_b32 v134, 16, v134
NOX0:
    s_cmp_lt_u32 s50, 24
    s_cselect_b32 s67, s48, 7
    s_cmp_lt_u32 s67, 4
    s_cbranch_scc0 NOQW
WC_3:
    ds_read_b32 v0, v147 offset:0
    s_sub_u32 s56, s56, 1
    s_cbranch_scc1 EXIT
    s_waitcnt lgkmcnt(0)
    v_cmp_le_i32 vcc, 8, v0
    s_cbranch_vccz WC_3
    ds_read_b64_tr_b16 v[68:69], v142 offset:0
    ds_read_b64_tr_b16 v[70:71], v142 offset:512
    ds_read_b64_tr_b16 v[72:73], v142 offset:4096
    ds_read_b64_tr_b16 v[74:75], v142 offset:4608
    ds_read_b64_tr_b16 v[76:77], v142 offset:8192
    ds_read_b64_tr_b16 v[78:79], v142 offset:8704
    ds_read_b64_tr_b16 v[80:81], v142 offset:12288
    ds_read_b64_tr_b16 v[82:83], v142 offset:12800
    ds_read_b64_tr_b16 v[84:85], v142 offset:16384
    ds_read_b64_tr_b16 v[86:87], v142 offset:16896
    ds_read_b64_tr_b16 v[88:89], v142 offset:20480
    ds_read_b64_tr_b16 v[90:91], v142 offset:20992
NOQW:
PAIR:
    s_cmp_lt_u32 s50, 24
    s_cbranch_scc0 QDONE
    v_mov_b64 v[128:129], 0
    v_mov_b64 v[130:131], 0
    v_mov_b64 v[124:125], 0
    s_cmp_eq_u32 s54, 0
    s_cbranch_scc1 P0_4
    s_waitcnt lgkmcnt(0)
    s_barrier
P0_4b:
    s_cmp_lt_u32 s48, 4
    s_cbranch_scc0 QST
    ds_read_b128 v[92:95], v144 offset:128
    ds_read_b128 v[96:99], v144 offset:256
    ds_read_b128 v[100:103], v144 offset:384
    s_waitcnt lgkmcnt(2)
    v_smfmac_f32_16x16x64_bf16 v[128:131], v[92:95], v[68:75], v141
    s_waitcnt lgkmcnt(1)
    v_smfmac_f32_16x16x64_bf16 v[128:131], v[96:99], v[76:83], v141
    s_waitcnt lgkmcnt(0)
    v_smfmac_f32_16x16x64_bf16 v[128:131], v[100:103], v[84:91], v141
    s_mov_b64 exec, s[84:85]
    s_nop 6
    v_add_f32 v120, v128, v130
    s_cmp_eq_u32 s55, 2
    s_cbranch_scc0 PS_6
    buffer_store_dword v120, v148, s[40:43], s57 offen
PS_6b:
    s_mov_b64 exec, -1
QDONE:
    s_cmp_lt_u32 s48, 4
    s_cbranch_scc0 QKW
    s_cmp_eq_u32 s54, 0
    s_cbranch_scc1 P0_8
H1:
    buffer_load_dwordx2 v[92:93], v154, s[40:43], s57 offen offset:0 sc1
    buffer_load_dwordx2 v[94:95], v154, s[40:43], s57 offen offset:384 sc1
    buffer_load_dwordx2 v[96:97], v154, s[40:43], s57 offen offset:768 sc1
    s_sub_u32 s56, s56, 1
    s_cbranch_scc1 EXIT
    s_waitcnt vmcnt(0)
    v_max3_u32 v124, v92, v93, v94
    v_max3_u32 v125, v95, v96, v97
    v_pk_add_f32 v[120:121], v[92:93], v[94:95]
    v_max_u32 v124, v124, v125
    v_cmp_eq_u32 vcc, -1, v124
    v_pk_add_f32 v[120:121], v[120:121], v[96:97]
    s_cbranch_vccnz H1
H1C:
    v_readlane_b32 s4, v120, 32
    v_readlane_b32 s5, v121, 32
    s_nop 0
    v_fma_f32 v120, s4, v132, v120
    v_fma_f32 v121, s4, v133, v121
    s_mov_b32 exec_hi, 0
    v_cvt_pk_bf16_f32 v120, v120, v121
    ds_write_b32 v145, v120
    s_mov_b32 exec_hi, -1
    s_cmp_eq_u32 s54, 0
    s_cbranch_scc1 P0_11
    s_waitcnt lgkmcnt(0)
    s_barrier
P0_11b:
    v_mul_f32 v123, s4, v163
    v_mul_f32 v122, s5, v163
    v_fma_f32 v122, -v123, v123, v122
    v_max_f32 v122, 0, v122
    v_add_f32 v122, 0x3727c5ac, v122
    v_rsq_f32 v122, v122
    v_mov_b64 v[68:69], 0
    v_mov_b64 v[70:71], 0
    v_mov_b64 v[72:73], 0
    v_mov_b64 v[74:75], 0
    v_mov_b64 v[76:77], 0
    v_mov_b64 v[78:79], 0
    v_mov_b64 v[80:81], 0
    v_mov_b64 v[82:83], 0
    v_mov_b64 v[84:85], 0
    v_mov_b64 v[86:87], 0
    v_mov_b64 v[88:89], 0
    v_mov_b64 v[90:91], 0
    v_mov_b64 v[92:93], 0
    v_mov_b64 v[94:95], 0
    v_mov_b64 v[96:97], 0
    v_mov_b64 v[98:99], 0
    v_mov_b64 v[100:101], 0
    v_mov_b64 v[102:103], 0
    v_mov_b32 v124, s61
    v_mov_b32 v125, s61
    v_mov_b32 v126, s61
    v_mov_b32 v127, s61
    v_mov_b32 v128, s61
    v_mov_b32 v129, s61
    v_mov_b32 v130, s61
    v_mov_b32 v131, s61
    v_mul_f32 v140, s63, v122
    s_cmp_eq_u32 s54, 0
    s_cbranch_scc1 P0_12
    s_waitcnt lgkmcnt(0)
    s_barrier
P0_12b:
    ds_read_b128 v[104:107], v146
    ds_read_b128 v[108:111], v146 offset:1024
    s_waitcnt lgkmcnt(1)
    v_max3_f32 v120, v104, v105, v106
    s_waitcnt lgkmcnt(0)
    v_max3_f32 v122, v107, v108, v109
    v_max3_f32 v120, v120, v110, v111
    v_max_f32 v120, v120, v122
    s_nop 1
    v_max_f32_dpp v120, v120, v120 quad_perm:[2,3,0,1] row_mask:0xf bank_mask:0xf
    s_nop 1
    v_max_f32_dpp v120, v120, v120 row_ror:4 row_mask:0xf bank_mask:0xf
    s_nop 1
    v_max_f32_dpp v120, v120, v120 row_ror:8 row_mask:0xf bank_mask:0xf
    v_mov_b32 v122, v120
    s_nop 1
    v_permlane16_swap_b32 v120, v122
    v_max_f32 v120, v120, v122
    v_mov_b32 v122, v120
    s_nop 1
    v_permlane32_swap_b32 v120, v122
    v_max_f32 v120, v120, v122
    v_mul_f32 v120, v140, v120
    v_pk_fma_f32 v[104:105], v[104:105], v[140:141], v[120:121] op_sel_hi:[1,0,0] neg_lo:[0,0,1] neg_hi:[0,0,1]
    v_pk_fma_f32 v[106:107], v[106:107], v[140:141], v[120:121] op_sel_hi:[1,0,0] neg_lo:[0,0,1] neg_hi:[0,0,1]
    v_pk_fma_f32 v[108:109], v[108:109], v[140:141], v[120:121] op_sel_hi:[1,0,0] neg_lo:[0,0,1] neg_hi:[0,0,1]
    v_pk_fma_f32 v[110:111], v[110:111], v[140:141], v[120:121] op_sel_hi:[1,0,0] neg_lo:[0,0,1] neg_hi:[0,0,1]
    v_exp_f32 v104, v104
    v_exp_f32 v105, v105
    v_exp_f32 v106, v106
    v_exp_f32 v107, v107
    v_cvt_pk_bf16_f32 v112, v104, v105
    v_exp_f32 v108, v108
    v_exp_f32 v109, v109
    v_cvt_pk_bf16_f32 v113, v106, v107
    v_exp_f32 v110, v110
    v_exp_f32 v111, v111
    v_cvt_pk_bf16_f32 v114, v108, v109
    v_cvt_pk_bf16_f32 v115, v110, v111
    s_cmp_eq_u32 s54, 0
    s_cbranch_scc1 P0_20
P0_20b:
    v_smfmac_f32_16x16x64_bf16 v[100:103], v[112:115], v[124:131], v141
    v_smfmac_f32_16x16x64_bf16 v[68:71], v[112:115], v[4:11], v141
    v_smfmac_f32_16x16x64_bf16 v[84:87], v[112:115], v[36:43], v141
    v_smfmac_f32_16x16x64_bf16 v[72:75], v[112:115], v[12:19], v141
    v_smfmac_f32_16x16x64_bf16 v[88:91], v[112:115], v[44:51], v141
    v_smfmac_f32_16x16x64_bf16 v[76:79], v[112:115], v[20:27], v141
    s_nop 2
    v_pk_add_f32 v[100:101], v[100:101], v[102:103]
    v_smfmac_f32_16x16x64_bf16 v[92:95], v[112:115], v[52:59], v141
    s_nop 0
    v_permlane32_swap_b32 v100, v101
    v_smfmac_f32_16x16x64_bf16 v[80:83], v[112:115], v[28:35], v141
    v_add_f32 v121, v100, v101
    v_add_f32 v122, v100, v101
    v_smfmac_f32_16x16x64_bf16 v[96:99], v[112:115], v[60:67], v141
    s_nop 0
    v_permlane16_swap_b32 v121, v122
    v_add_f32 v121, v121, v122
    s_mov_b64 exec, s[76:77]
    v_pk_add_f32 v[104:105], v[68:69], v[70:71]
    v_pk_add_f32 v[106:107], v[84:85], v[86:87]
    s_mov_b64 exec, s[78:79]
    v_pk_add_f32 v[104:105], v[72:73], v[74:75]
    v_pk_add_f32 v[106:107], v[88:89], v[90:91]
    s_mov_b64 exec, s[80:81]
    v_pk_add_f32 v[104:105], v[76:77], v[78:79]
    v_pk_add_f32 v[106:107], v[92:93], v[94:95]
    s_mov_b64 exec, s[82:83]
    v_pk_add_f32 v[104:105], v[80:81], v[82:83]
    v_pk_add_f32 v[106:107], v[96:97], v[98:99]
    s_mov_b64 exec, -1
    v_permlane32_swap_b32 v104, v105
    v_permlane32_swap_b32 v106, v107
    v_add_f32 v104, v104, v105
    v_add_f32 v106, v106, v107
    s_nop 1
    v_permlane16_swap_b32 v104, v106
    v_add_f32 v104, v104, v106
    s_nop 1
    v_mov_b32_dpp v105, v104 quad_perm:[1,1,3,3] row_mask:0xf bank_mask:0xf
    s_mov_b32 exec_lo, 0x55555555
    s_mov_b32 exec_hi, 0x55555555
    v_cvt_pk_bf16_f32 v104, v104, v105
    s_cmp_eq_u32 s55, 2
    s_cbranch_scc0 PO_25
    buffer_store_dword v104, v151, s[40:43], s57 offen
    s_mov_b32 exec_lo, 1
    s_mov_b32 exec_hi, 2
    buffer_store_dwordx2 v[120:121], v152, s[40:43], s57 offen
PO_25b:
    s_mov_b64 exec, -1
    s_cmp_lt_u32 s50, 27
    s_cbranch_scc0 NEXT
    s_cmp_eq_u32 s54, 0
    s_cbranch_scc1 P0_26
    ds_read_b64_tr_b16 v[68:69], v142 offset:24576
    ds_read_b64_tr_b16 v[70:71], v142 offset:25088
    ds_read_b64_tr_b16 v[72:73], v142 offset:28672
    ds_read_b64_tr_b16 v[74:75], v142 offset:29184
    ds_read_b64_tr_b16 v[76:77], v142 offset:32768
    ds_read_b64_tr_b16 v[78:79], v142 offset:33280
    ds_read_b64_tr_b16 v[80:81], v142 offset:36864
    ds_read_b64_tr_b16 v[82:83], v142 offset:37376
    ds_read_b64_tr_b16 v[84:85], v142 offset:40960
    ds_read_b64_tr_b16 v[86:87], v142 offset:41472
    ds_read_b64_tr_b16 v[88:89], v142 offset:45056
    ds_read_b64_tr_b16 v[90:91], v142 offset:45568
P0_26:
    s_cmp_lt_u32 s48, 3
    s_cbranch_scc0 H2DONE
H2:
    buffer_load_dwordx2 v[100:101], v156, s[40:43], s57 offen sc1
    buffer_load_dwordx2 v[102:103], v156, s[40:43], s57 offen offset:16 sc1
    buffer_load_dwordx4 v[92:95], v155, s[40:43], s57 offen sc1
    buffer_load_dwordx4 v[96:99], v155, s[40:43], s57 offen offset:512 sc1
    s_sub_u32 s56, s56, 1
    s_cbranch_scc1 EXIT
    s_waitcnt vmcnt(2)
    v_max_f32 v120, v100, v102
    v_max3_u32 v121, v100, v101, v102
    v_max_u32 v121, v121, v103
    v_max_f32_dpp v120, v120, v120 row_ror:8 row_mask:0xf bank_mask:0xf
    v_mov_b32 v122, v120
    s_waitcnt vmcnt(0)
    v_max3_u32 v121, v121, v92, v93
    v_permlane16_swap_b32 v120, v122
    v_max3_u32 v121, v121, v94, v95
    v_max_f32 v120, v120, v122
    v_mov_b32 v122, v120
    v_max3_u32 v121, v121, v96, v97
    v_max3_u32 v121, v121, v98, v99
    v_permlane32_swap_b32 v120, v122
    v_cmp_eq_u32 vcc, -1, v121
    v_max_f32 v120, v120, v122
    s_cbranch_vccnz H2
    v_sub_f32 v124, v100, v120
    v_sub_f32 v126, v102, v120
    v_exp_f32 v124, v124
    v_exp_f32 v126, v126
    v_lshlrev_b32 v104, 16, v92
    v_and_b32 v105, 0xffff0000, v92
    v_lshlrev_b32 v106, 16, v93
    v_and_b32 v107, 0xffff0000, v93
    v_lshlrev_b32 v108, 16, v94
    v_and_b32 v109, 0xffff0000, v94
    v_lshlrev_b32 v110, 16, v95
    v_and_b32 v111, 0xffff0000, v95
    v_lshlrev_b32 v112, 16, v96
    v_and_b32 v113, 0xffff0000, v96
    v_lshlrev_b32 v114, 16, v97
    v_and_b32 v115, 0xffff0000, v97
    v_lshlrev_b32 v116, 16, v98
    v_and_b32 v117, 0xffff0000, v98
    v_lshlrev_b32 v118, 16, v99
    v_and_b32 v119, 0xffff0000, v99
    v_mul_f32 v123, v101, v124
    v_fmac_f32 v123, v103, v126
    v_pk_mul_f32 v[104:105], v[104:105], v[124:125] op_sel_hi:[1,0]
    s_nop 0
    v_add_f32_dpp v123, v123, v123 row_ror:8 row_mask:0xf bank_mask:0xf
    v_pk_mul_f32 v[106:107], v[106:107], v[124:125] op_sel_hi:[1,0]
    v_pk_mul_f32 v[108:109], v[108:109], v[124:125] op_sel_hi:[1,0]
    v_pk_mul_f32 v[110:111], v[110:111], v[124:125] op_sel_hi:[1,0]
    v_mov_b32 v122, v123
    v_pk_fma_f32 v[104:105], v[112:113], v[126:127], v[104:105] op_sel_hi:[1,0,1]
    v_pk_fma_f32 v[106:107], v[114:115], v[126:127], v[106:107] op_sel_hi:[1,0,1]
    v_permlane16_swap_b32 v123, v122
    v_pk_fma_f32 v[108:109], v[116:117], v[126:127], v[108:109] op_sel_hi:[1,0,1]
    v_pk_fma_f32 v[110:111], v[118:119], v[126:127], v[110:111] op_sel_hi:[1,0,1]
    v_add_f32 v123, v123, v122
    v_mov_b32 v122, v123
    v_permlane32_swap_b32 v104, v108
    v_permlane32_swap_b32 v105, v109
    v_permlane32_swap_b32 v106, v110
    v_permlane32_swap_b32 v107, v111
    v_permlane32_swap_b32 v123, v122
    v_pk_add_f32 v[104:105], v[104:105], v[108:109]
    v_pk_add_f32 v[106:107], v[106:107], v[110:111]
    v_add_f32 v123, v123, v122
    v_rcp_f32 v123, v123
    v_permlane16_swap_b32 v104, v106
    v_permlane16_swap_b32 v105, v107
    v_pk_add_f32 v[104:105], v[104:105], v[106:107]
    s_nop 1
    v_add_f32_dpp v104, v104, v104 row_ror:8 row_mask:0xf bank_mask:0xf
    v_add_f32_dpp v105, v105, v105 row_ror:8 row_mask:0xf bank_mask:0xf
    v_mul_f32 v104, v104, v123
    v_mul_f32 v105, v105, v123
    s_mov_b64 exec, s[8:9]
    v_cvt_pk_bf16_f32 v104, v104, v105
    ds_write_b32 v159, v104 offset:512
    s_mov_b64 exec, -1
H2DONE:
    v_mov_b64 v[128:129], 0
    v_mov_b64 v[130:131], 0
    s_cmp_eq_u32 s54, 0
    s_cbranch_scc1 P0_27
    s_waitcnt lgkmcnt(0)
    s_barrier
P0_27b:
    ds_read_b128 v[92:95], v144 offset:512
    ds_read_b128 v[96:99], v144 offset:640
    ds_read_b128 v[100:103], v144 offset:768
    s_waitcnt lgkmcnt(2)
    v_smfmac_f32_16x16x64_bf16 v[128:131], v[92:95], v[68:75], v141
    s_waitcnt lgkmcnt(1)
    v_smfmac_f32_16x16x64_bf16 v[128:131], v[96:99], v[76:83], v141
    s_waitcnt lgkmcnt(0)
    v_smfmac_f32_16x16x64_bf16 v[128:131], v[100:103], v[84:91], v141
    s_nop 7
    v_add_f32 v120, v128, v130
    s_nop 1
    v_mov_b32_dpp v121, v120 quad_perm:[1,1,3,3] row_mask:0xf bank_mask:0xf
    s_mov_b64 exec, 0x5555
    v_cvt_pk_bf16_f32 v120, v120, v121
    ds_write_b32 v150, v120
    s_mov_b64 exec, -1
    s_cmp_eq_u32 s54, 0
    s_cbranch_scc1 P0_33
    ds_read_b64_tr_b16 v[68:69], v143 offset:0
    ds_read_b64_tr_b16 v[70:71], v143 offset:512
    ds_read_b64_tr_b16 v[72:73], v143 offset:4096
    ds_read_b64_tr_b16 v[74:75], v143 offset:4608
    ds_read_b64_tr_b16 v[76:77], v143 offset:8192
    ds_read_b64_tr_b16 v[78:79], v143 offset:8704
    ds_read_b64_tr_b16 v[80:81], v143 offset:12288
    ds_read_b64_tr_b16 v[82:83], v143 offset:12800
    ds_read_b64_tr_b16 v[84:85], v143 offset:16384
    ds_read_b64_tr_b16 v[86:87], v143 offset:16896
    ds_read_b64_tr_b16 v[88:89], v143 offset:20480
    ds_read_b64_tr_b16 v[90:91], v143 offset:20992
    s_cmp_lt_u32 s48, 3
    s_cbranch_scc0 G1DONE
    s_sleep 13
G1:
    buffer_load_dwordx4 v[92:95], v157, s[40:43], s58 offen offset:0 sc1
    buffer_load_dwordx4 v[96:99], v157, s[40:43], s58 offen offset:1152 sc1
    buffer_load_dwordx4 v[100:103], v157, s[40:43], s58 offen offset:2304 sc1
    s_sub_u32 s56, s56, 1
    s_cbranch_scc1 EXIT
G1_w:
    s_waitcnt vmcnt(2)
    v_lshlrev_b32 v104, 16, v92
    v_and_b32 v105, 0xffff0000, v92
    v_lshlrev_b32 v106, 16, v93
    v_and_b32 v107, 0xffff0000, v93
    v_lshlrev_b32 v108, 16, v94
    v_and_b32 v109, 0xffff0000, v94
    v_lshlrev_b32 v110, 16, v95
    v_and_b32 v111, 0xffff0000, v95
    v_max3_u32 v120, v92, v93, v94
    s_waitcnt vmcnt(1)
    v_dot2c_f32_bf16 v104, s59, v96
    v_dot2c_f32_bf16 v105, s60, v96
    v_dot2c_f32_bf16 v106, s59, v97
    v_dot2c_f32_bf16 v107, s60, v97
    v_dot2c_f32_bf16 v108, s59, v98
    v_dot2c_f32_bf16 v109, s60, v98
    v_dot2c_f32_bf16 v110, s59, v99
    v_dot2c_f32_bf16 v111, s60, v99
    v_max3_u32 v120, v120, v95, v96
    v_max3_u32 v121, v97, v98, v99
    s_waitcnt vmcnt(0)
    v_max3_u32 v120, v120, v100, v101
    v_max3_u32 v121, v121, v102, v103
    v_dot2c_f32_bf16 v104, s59, v100
    v_dot2c_f32_bf16 v108, s59, v102
    v_dot2c_f32_bf16 v105, s60, v100
    v_dot2c_f32_bf16 v109, s60, v102
    v_max_u32 v120, v120, v121
    v_dot2c_f32_bf16 v106, s59, v101
    v_dot2c_f32_bf16 v110, s59, v103
    v_cmp_eq_u32 vcc, -1, v120
    v_dot2c_f32_bf16 v107, s60, v101
    v_dot2c_f32_bf16 v111, s60, v103
    s_cbranch_vccnz G1
    v_permlane32_swap_b32 v104, v108
    v_permlane32_swap_b32 v105, v109
    v_permlane32_swap_b32 v106, v110
    v_permlane32_swap_b32 v107, v111
    v_pk_add_f32 v[104:105], v[104:105], v[108:109]
    v_pk_add_f32 v[106:107], v[106:107], v[110:111]
    s_nop 1
    v_permlane16_swap_b32 v104, v106
    v_permlane16_swap_b32 v105, v107
    v_pk_add_f32 v[104:105], v[104:105], v[106:107]
    s_nop 1
    v_add_f32_dpp v104, v104, v104 row_ror:8 row_mask:0xf bank_mask:0xf
    v_add_f32_dpp v105, v105, v105 row_ror:8 row_mask:0xf bank_mask:0xf
    v_pk_add_f32 v[104:105], v[104:105], v[134:135]
    v_cvt_pk_bf16_f32 v120, v104, v105
    s_mov_b32 exec_lo, 0x00ff00ff
    s_mov_b32 exec_hi, 0x00ff00ff
    ds_write_b32 v159, v120 offset:128
    s_mov_b64 exec, -1
    v_lshlrev_b32 v134, 16, v120
    v_and_b32 v135, 0xffff0000, v120
G1DONE:
    v_mov_b64 v[128:129], 0
    v_mov_b64 v[130:131], 0
    v_mov_b64 v[124:125], 0
    s_cmp_eq_u32 s54, 0
    s_cbranch_scc1 P0_36
    s_waitcnt lgkmcnt(0)
    s_barrier
P0_36b:
    s_cmp_eq_u32 s48, 7
    s_cbranch_scc1 GST
GNST:
    ds_read_b128 v[92:95], v144 offset:128
    ds_read_b128 v[96:99], v144 offset:256
    ds_read_b128 v[100:103], v144 offset:384
    s_waitcnt lgkmcnt(2)
    v_smfmac_f32_16x16x64_bf16 v[128:131], v[92:95], v[68:75], v141
    s_waitcnt lgkmcnt(1)
    v_smfmac_f32_16x16x64_bf16 v[128:131], v[96:99], v[76:83], v141
    s_waitcnt lgkmcnt(0)
    v_smfmac_f32_16x16x64_bf16 v[128:131], v[100:103], v[84:91], v141
    s_mov_b64 exec, s[84:85]
    s_nop 6
    v_add_f32 v120, v128, v130
    s_cmp_eq_u32 s55, 2
    s_cbranch_scc0 PS_39
    buffer_store_dword v120, v149, s[40:43], s57 offen
PS_39b:
    s_mov_b64 exec, -1
    s_add_u32 s74, s58, 32768
    s_cmp_lt_u32 s48, 4
    s_cbranch_scc0 DNOM
    v_add_u32 v165, 114688, v142
    s_cmp_eq_u32 s54, 0
    s_cbranch_scc1 P0_40
    ds_read_b64_tr_b16 v[68:69], v165 offset:0
    ds_read_b64_tr_b16 v[70:71], v165 offset:512
    ds_read_b64_tr_b16 v[72:73], v165 offset:4096
    ds_read_b64_tr_b16 v[74:75], v165 offset:4608
    ds_read_b64_tr_b16 v[76:77], v165 offset:8192
    ds_read_b64_tr_b16 v[78:79], v165 offset:8704
    ds_read_b64_tr_b16 v[80:81], v165 offset:12288
    ds_read_b64_tr_b16 v[82:83], v165 offset:12800
    ds_read_b64_tr_b16 v[84:85], v165 offset:16384
    ds_read_b64_tr_b16 v[86:87], v165 offset:16896
    ds_read_b64_tr_b16 v[88:89], v165 offset:20480
    ds_read_b64_tr_b16 v[90:91], v165 offset:20992
    s_cmp_lt_u32 s48, 3
    s_cbranch_scc0 H5DONE
H5:
    buffer_load_dwordx4 v[92:95], v158, s[40:43], s57 offen offset:0 sc1
    buffer_load_dwordx4 v[96:99], v158, s[40:43], s57 offen offset:640 sc1
    buffer_load_dwordx4 v[100:103], v158, s[40:43], s57 offen offset:1280 sc1
    s_sub_u32 s56, s56, 1
    s_cbranch_scc1 EXIT
    s_waitcnt vmcnt(0)
    v_max3_u32 v124, v92, v93, v94
    v_max3_u32 v124, v124, v95, v96
    v_max_u32 v124, v124, v97
    v_max3_u32 v125, v98, v99, v100
    v_max3_u32 v125, v125, v101, v102
    v_max_u32 v125, v125, v103
    v_pk_add_f32 v[120:121], v[92:93], v[96:97]
    v_pk_add_f32 v[122:123], v[94:95], v[98:99]
    v_max_u32 v124, v124, v125
    v_cmp_eq_u32 vcc, -1, v124
    v_pk_add_f32 v[120:121], v[120:121], v[100:101]
    v_pk_add_f32 v[122:123], v[122:123], v[102:103]
    s_cbranch_vccnz H5
H5C:
    v_readlane_b32 s4, v120, 32
    v_readlane_b32 s5, v121, 32
    s_nop 0
    v_mul_f32 v128, s4, v163
    v_mul_f32 v126, s5, v163
    v_fma_f32 v120, s4, v136, v120
    v_fma_f32 v126, -v128, v128, v126
    v_fma_f32 v121, s4, v137, v121
    v_max_f32 v126, 0, v126
    v_fma_f32 v122, s4, v138, v122
    v_add_f32 v126, 0x3727c5ac, v126
    v_fma_f32 v123, s4, v139, v123
    v_rsq_f32 v126, v126
    v_mov_b64 v[104:105], v[120:121]
    v_mov_b64 v[106:107], v[122:123]
    s_nop 0
    v_permlane16_swap_b32 v120, v104
    v_permlane16_swap_b32 v121, v105
    v_permlane16_swap_b32 v122, v106
    v_permlane16_swap_b32 v123, v107
    v_pk_mul_f32 v[120:121], v[120:121], v[126:127] op_sel_hi:[1,0]
    v_pk_mul_f32 v[104:105], v[104:105], v[126:127] op_sel_hi:[1,0]
    v_pk_mul_f32 v[122:123], v[122:123], v[126:127] op_sel_hi:[1,0]
    v_pk_mul_f32 v[106:107], v[106:107], v[126:127] op_sel_hi:[1,0]
    v_pk_mul_f32 v[120:121], v[120:121], v[104:105]
    v_pk_mul_f32 v[122:123], v[122:123], v[106:107]
    s_mov_b64 exec, 0xffff
    v_cvt_pk_bf16_f32 v120, v120, v121
    v_cvt_pk_bf16_f32 v121, v122, v123
    ds_write2_b32 v160, v120, v121 offset0:0 offset1:16
    s_mov_b64 exec, -1
H5DONE:
    v_mov_b64 v[128:129], 0
    v_mov_b64 v[130:131], 0
    s_waitcnt lgkmcnt(0)
    s_barrier
    s_cmp_eq_u32 s54, 0
    s_cbranch_scc1 P0_41
P0_41b:
    ds_read_b128 v[92:95], v144 offset:896
    ds_read_b128 v[96:99], v144 offset:1024
    ds_read_b128 v[100:103], v144 offset:1152
    s_waitcnt lgkmcnt(2)
    v_smfmac_f32_16x16x64_bf16 v[128:131], v[92:95], v[68:75], v141
    s_waitcnt lgkmcnt(1)
    v_smfmac_f32_16x16x64_bf16 v[128:131], v[96:99], v[76:83], v141
    s_waitcnt lgkmcnt(0)
    v_smfmac_f32_16x16x64_bf16 v[128:131], v[100:103], v[84:91], v141
    s_nop 7
    v_add_f32 v120, v128, v130
    s_nop 1
    v_mov_b32_dpp v121, v120 quad_perm:[1,1,3,3] row_mask:0xf bank_mask:0xf
    s_mov_b64 exec, 0x5555
    v_cvt_pk_bf16_f32 v120, v120, v121
    ds_write_b32 v150, v120
    s_mov_b64 exec, -1
    s_cmp_eq_u32 s54, 0
    s_cbranch_scc1 P0_42
    s_or_b32 s67, s49, s51
    s_cmp_eq_u32 s67, 0
    s_cbranch_scc0 EXIT
    s_cmp_lt_u32 s48, 3
    s_cbranch_scc0 EXIT
    s_mov_b32 s44, s34
    s_mov_b32 s45, s35
    s_mov_b32 s46, 1152
    s_mov_b32 s47, 0x20000
    s_sleep 13
G2:
    buffer_load_dwordx4 v[92:95], v157, s[40:43], s74 offen offset:0 sc1
    buffer_load_dwordx4 v[96:99], v157, s[40:43], s74 offen offset:1152 sc1
    buffer_load_dwordx4 v[100:103], v157, s[40:43], s74 offen offset:2304 sc1
    s_sub_u32 s56, s56, 1
    s_cbranch_scc1 EXIT
G2_w:
    s_waitcnt vmcnt(2)
    v_lshlrev_b32 v104, 16, v92
    v_and_b32 v105, 0xffff0000, v92
    v_lshlrev_b32 v106, 16, v93
    v_and_b32 v107, 0xffff0000, v93
    v_lshlrev_b32 v108, 16, v94
    v_and_b32 v109, 0xffff0000, v94
    v_lshlrev_b32 v110, 16, v95
    v_and_b32 v111, 0xffff0000, v95
    v_max3_u32 v120, v92, v93, v94
    s_waitcnt vmcnt(1)
    v_dot2c_f32_bf16 v104, s59, v96
    v_dot2c_f32_bf16 v105, s60, v96
    v_dot2c_f32_bf16 v106, s59, v97
    v_dot2c_f32_bf16 v107, s60, v97
    v_dot2c_f32_bf16 v108, s59, v98
    v_dot2c_f32_bf16 v109, s60, v98
    v_dot2c_f32_bf16 v110, s59, v99
    v_dot2c_f32_bf16 v111, s60, v99
    v_max3_u32 v120, v120, v95, v96
    v_max3_u32 v121, v97, v98, v99
    s_waitcnt vmcnt(0)
    v_max3_u32 v120, v120, v100, v101
    v_max3_u32 v121, v121, v102, v103
    v_dot2c_f32_bf16 v104, s59, v100
    v_dot2c_f32_bf16 v108, s59, v102
    v_dot2c_f32_bf16 v105, s60, v100
    v_dot2c_f32_bf16 v109, s60, v102
    v_max_u32 v120, v120, v121
    v_dot2c_f32_bf16 v106, s59, v101
    v_dot2c_f32_bf16 v110, s59, v103
    v_cmp_eq_u32 vcc, -1, v120
    v_dot2c_f32_bf16 v107, s60, v101
    v_dot2c_f32_bf16 v111, s60, v103
    s_cbranch_vccnz G2
    v_permlane32_swap_b32 v104, v108
    v_permlane32_swap_b32 v105, v109
    v_permlane32_swap_b32 v106, v110
    v_permlane32_swap_b32 v107, v111
    v_pk_add_f32 v[104:105], v[104:105], v[108:109]
    v_pk_add_f32 v[106:107], v[106:107], v[110:111]
    s_nop 1
    v_permlane16_swap_b32 v104, v106
    v_permlane16_swap_b32 v105, v107
    v_pk_add_f32 v[104:105], v[104:105], v[106:107]
    s_nop 1
    v_add_f32_dpp v104, v104, v104 row_ror:8 row_mask:0xf bank_mask:0xf
    v_add_f32_dpp v105, v105, v105 row_ror:8 row_mask:0xf bank_mask:0xf
    v_pk_add_f32 v[104:105], v[104:105], v[134:135]
    v_cvt_pk_bf16_f32 v120, v104, v105
    s_cmp_eq_u32 s54, 0
    s_cbranch_scc1 P0_43
    s_mov_b32 exec_lo, 0x00ff00ff
    s_mov_b32 exec_hi, 0x00ff00ff
    buffer_store_dword v120, v161, s[44:47], 0 offen
    s_branch EXIT
P0_43:
    s_mov_b32 exec_lo, 0x00ff00ff
    s_mov_b32 exec_hi, 0x00ff00ff
    ds_write_b32 v159, v120 offset:128
    s_mov_b64 exec, -1
    v_lshlrev_b32 v134, 16, v120
    v_and_b32 v135, 0xffff0000, v120
NEXT:
    s_cmp_eq_u32 s54, 0
    s_cbranch_scc0 EXIT
    s_mov_b32 s54, 1
    s_add_u32 s57, s57, 43392
    s_add_u32 s72, s72, 43392
    s_add_u32 s73, s73, 43392
    s_add_u32 s58, s58, 65536
    s_mov_b32 s84, 0xffff
    s_branch PAIR
P0_4:
    s_mov_b64 exec, 1
    ds_add_u32 v147, v162 offset:4
    s_mov_b64 exec, -1
WC_5:
    ds_read_b32 v0, v147 offset:4
    s_sub_u32 s56, s56, 1
    s_cbranch_scc1 EXIT
    s_waitcnt lgkmcnt(0)
    v_cmp_le_i32 vcc, 8, v0
    s_cbranch_vccz WC_5
    s_branch P0_4b
PS_6:
    buffer_store_dword v120, v148, s[40:43], s57 offen sc1
    s_branch PS_6b
PS_7:
    buffer_store_dword v126, v153, s[40:43], s72 offen sc1
    s_branch PS_7b
QST:
    s_cmp_eq_u32 s48, 7
    s_cbranch_scc0 QDONE
    s_mov_b32 exec_hi, 0xffff
    ds_read_b64 v[124:125], v164 offset:128
    s_mov_b32 exec_hi, -1
    v_mov_b64 v[126:127], 0
    s_waitcnt lgkmcnt(0)
    v_dot2c_f32_bf16 v126, s61, v124
    v_dot2c_f32_bf16 v127, v124, v124
    v_dot2c_f32_bf16 v126, s61, v125
    v_dot2c_f32_bf16 v127, v125, v125
    s_nop 2
    v_permlane32_swap_b32 v126, v127
    v_add_f32 v126, v126, v127
    v_mov_b32 v127, v126
    s_nop 1
    v_permlane16_swap_b32 v126, v127
    v_add_f32 v126, v126, v127
    s_nop 1
    v_add_f32_dpp v126, v126, v126 row_ror:8 row_mask:0xf bank_mask:0xf
    s_nop 1
    v_add_f32_dpp v126, v126, v126 row_ror:4 row_mask:0xf bank_mask:0xf
    s_nop 1
    v_add_f32_dpp v126, v126, v126 row_ror:2 row_mask:0xf bank_mask:0xf
    s_nop 1
    v_add_f32_dpp v126, v126, v126 row_ror:1 row_mask:0xf bank_mask:0xf
    s_mov_b32 exec_lo, 0x10001
    s_mov_b32 exec_hi, 0x10001
    s_cmp_eq_u32 s55, 2
    s_cbranch_scc0 PS_7
    buffer_store_dword v126, v153, s[40:43], s72 offen
PS_7b:
    s_mov_b64 exec, -1
    s_branch QDONE
P0_8:
WC_9:
    ds_read_b32 v0, v147 offset:20
    s_sub_u32 s56, s56, 1
    s_cbranch_scc1 EXIT
    s_waitcnt lgkmcnt(0)
    v_cmp_le_i32 vcc, 1, v0
    s_cbranch_vccz WC_9
    v_readfirstlane_b32 s55, v0
WC_10:
    ds_read_b32 v0, v147 offset:28
    s_sub_u32 s56, s56, 1
    s_cbranch_scc1 EXIT
    s_waitcnt lgkmcnt(0)
    v_cmp_le_i32 vcc, 24, v0
    s_cbranch_vccz WC_10
    v_mov_b64 v[104:105], 0
    v_mov_b64 v[106:107], 0
    v_mov_b64 v[108:109], 0
H1S:
    s_mov_b32 exec_lo, 0xffffffff
    s_mov_b32 exec_hi, 0x0
    buffer_load_dwordx2 v[104:105], v154, s[40:43], s65 offen offset:0 sc1
    buffer_load_dwordx2 v[106:107], v154, s[40:43], s65 offen offset:384 sc1
    buffer_load_dwordx2 v[108:109], v154, s[40:43], s65 offen offset:768 sc1
    s_mov_b64 exec, -1
    buffer_load_dwordx2 v[92:93], v154, s[40:43], s57 offen offset:0 sc1
    buffer_load_dwordx2 v[94:95], v154, s[40:43], s57 offen offset:384 sc1
    buffer_load_dwordx2 v[96:97], v154, s[40:43], s57 offen offset:768 sc1
    s_mov_b64 exec, 1
    ds_add_u32 v147, v162 offset:44
    s_mov_b64 exec, -1
    s_sub_u32 s56, s56, 1
    s_cbranch_scc1 EXIT
    s_waitcnt vmcnt(0)
    v_max3_u32 v124, v92, v93, v94
    v_max3_u32 v124, v124, v95, v96
    v_max_u32 v124, v124, v97
    v_max3_u32 v125, v104, v105, v106
    v_max3_u32 v125, v125, v107, v108
    v_max_u32 v125, v125, v109
    v_pk_add_f32 v[120:121], v[92:93], v[94:95]
    v_max_u32 v124, v124, v125
    v_cmp_eq_u32 vcc, -1, v124
    v_pk_add_f32 v[120:121], v[120:121], v[96:97]
    s_cbranch_vccnz H1S
    v_add_f32 v132, v104, v106
    v_add_f32 v132, v132, v108
    v_mul_f32 v132, 0xbae38e39, v132
    v_add_f32 v133, v105, v107
    v_add_f32 v133, v133, v109
    v_mul_f32 v133, 0xbae38e39, v133
    s_branch H1C
P0_11:
    s_mov_b64 exec, 1
    ds_add_u32 v147, v162 offset:8
    s_mov_b64 exec, -1
    s_branch P0_11b
P0_12:
    s_mov_b64 exec, 1
    ds_add_u32 v147, v162 offset:12
    s_mov_b64 exec, -1
WC_13:
    ds_read_b32 v0, v147 offset:12
    s_sub_u32 s56, s56, 1
    s_cbranch_scc1 EXIT
    s_waitcnt lgkmcnt(0)
    v_cmp_le_i32 vcc, 8, v0
    s_cbranch_vccz WC_13
    s_branch P0_12b
P0_15:
    s_mov_b64 exec, 1
    ds_add_u32 v147, v162 offset:8
    s_mov_b64 exec, -1
WC_16:
    ds_read_b32 v0, v147 offset:8
    s_sub_u32 s56, s56, 1
    s_cbranch_scc1 EXIT
    s_waitcnt lgkmcnt(0)
    v_cmp_le_i32 vcc, 8, v0
    s_cbranch_vccz WC_16
    s_branch P0_15b
P0_17:
    s_mov_b64 exec, 1
    ds_add_u32 v147, v162 offset:12
    s_mov_b64 exec, -1
    s_branch P0_17b
QKW:
    s_cmp_eq_u32 s54, 0
    s_cbranch_scc1 P0_14
P0_14b:
    v_mov_b64 v[104:105], 0
    v_mov_b64 v[106:107], 0
    v_mov_b64 v[108:109], 0
    v_mov_b64 v[110:111], 0
    v_mov_b64 v[112:113], 0
    v_mov_b64 v[114:115], 0
    v_mov_b64 v[116:117], 0
    v_mov_b64 v[118:119], 0
    s_cmp_eq_u32 s54, 0
    s_cbranch_scc1 P0_15
    s_waitcnt lgkmcnt(0)
    s_barrier
P0_15b:
    ds_read_b128 v[92:95], v145 offset:0
    ds_read_b128 v[96:99], v145 offset:128
    s_waitcnt lgkmcnt(1)
    v_smfmac_f32_16x16x64_bf16 v[104:107], v[92:95], v[4:11], v141
    v_smfmac_f32_16x16x64_bf16 v[108:111], v[92:95], v[20:27], v141
    v_smfmac_f32_16x16x64_bf16 v[112:115], v[92:95], v[36:43], v141
    v_smfmac_f32_16x16x64_bf16 v[116:119], v[92:95], v[52:59], v141
    s_waitcnt lgkmcnt(0)
    v_smfmac_f32_16x16x64_bf16 v[104:107], v[96:99], v[12:19], v141
    v_smfmac_f32_16x16x64_bf16 v[108:111], v[96:99], v[28:35], v141
    v_smfmac_f32_16x16x64_bf16 v[112:115], v[96:99], v[44:51], v141
    v_smfmac_f32_16x16x64_bf16 v[116:119], v[96:99], v[60:67], v141
    s_mov_b64 exec, s[76:77]
    s_nop 3
    v_pk_add_f32 v[120:121], v[104:105], v[106:107]
    s_mov_b64 exec, s[78:79]
    v_pk_add_f32 v[120:121], v[108:109], v[110:111]
    s_mov_b64 exec, s[80:81]
    v_pk_add_f32 v[120:121], v[112:113], v[114:115]
    s_mov_b64 exec, s[82:83]
    v_pk_add_f32 v[120:121], v[116:117], v[118:119]
    s_mov_b64 exec, -1
    ds_write2_b32 v146, v120, v121 offset0:0 offset1:4
    s_cmp_eq_u32 s54, 0
    s_cbranch_scc1 P0_17
    s_waitcnt lgkmcnt(0)
    s_barrier
P0_17b:
    s_cmp_eq_u32 s48, 6
    s_cselect_b32 s67, s54, 1
    s_cmp_eq_u32 s67, 0
    s_cbranch_scc0 ATTD
    v_and_b32 v125, 7, v1
    v_lshlrev_b32 v125, 5, v125
ALLW:
    buffer_load_dword v124, v125, s[44:47], 0 offen sc1
    s_sub_u32 s56, s56, 1
    s_cbranch_scc1 EXIT
    s_waitcnt vmcnt(0)
    v_add_u32 v124, -1, v124
    v_and_b32 v126, 31, v124
    v_cmp_ne_u32 vcc, 31, v126
    s_cbranch_vccnz ALLW
    v_cmp_eq_u32 vcc, -1, v124
    s_cbranch_vccnz ALLW
    s_mov_b64 exec, 1
    ds_write_b32 v147, v162 offset:24
    s_mov_b64 exec, -1
    s_branch ATTD
P0_14:
WC_18:
    ds_read_b32 v0, v147 offset:20
    s_sub_u32 s56, s56, 1
    s_cbranch_scc1 EXIT
    s_waitcnt lgkmcnt(0)
    v_cmp_le_i32 vcc, 1, v0
    s_cbranch_vccz WC_18
    v_readfirstlane_b32 s55, v0
WC_19:
    ds_read_b32 v0, v147 offset:28
    s_sub_u32 s56, s56, 1
    s_cbranch_scc1 EXIT
    s_waitcnt lgkmcnt(0)
    v_cmp_le_i32 vcc, 64, v0
    s_cbranch_vccz WC_19
    v_xor_b32 v121, 64, v165
    v_xor_b32 v122, 0x80, v165
    v_xor_b32 v123, 0xc0, v165
    ds_read_b128 v[4:7], v165 offset:0
    ds_read_b128 v[8:11], v121 offset:0
    ds_read_b128 v[12:15], v122 offset:0
    ds_read_b128 v[16:19], v123 offset:0
    ds_read_b128 v[20:23], v165 offset:4096
    ds_read_b128 v[24:27], v121 offset:4096
    ds_read_b128 v[28:31], v122 offset:4096
    ds_read_b128 v[32:35], v123 offset:4096
    ds_read_b128 v[36:39], v165 offset:8192
    ds_read_b128 v[40:43], v121 offset:8192
    ds_read_b128 v[44:47], v122 offset:8192
    ds_read_b128 v[48:51], v123 offset:8192
    s_waitcnt lgkmcnt(4)
    ds_read_b128 v[52:55], v165 offset:12288
    ds_read_b128 v[56:59], v121 offset:12288
    ds_read_b128 v[60:63], v122 offset:12288
    ds_read_b128 v[64:67], v123 offset:12288
    s_waitcnt lgkmcnt(0)
    s_mov_b64 exec, 1
    ds_add_u32 v147, v162 offset:32
    s_mov_b64 exec, -1
    s_branch P0_14b
P0_20:
    v_xor_b32 v122, 32, v165
WC_21:
    ds_read_b32 v0, v147 offset:28
    s_sub_u32 s56, s56, 1
    s_cbranch_scc1 EXIT
    s_waitcnt lgkmcnt(0)
    v_cmp_le_i32 vcc, 80, v0
    s_cbranch_vccz WC_21
VRD0:
    ds_read_b64_tr_b16 v[4:5], v165 offset:0
    ds_read_b64_tr_b16 v[6:7], v165 offset:1024
    ds_read_b64_tr_b16 v[36:37], v122 offset:0
    ds_read_b64_tr_b16 v[38:39], v122 offset:1024
    ds_read_b64_tr_b16 v[8:9], v165 offset:8192
    ds_read_b64_tr_b16 v[10:11], v165 offset:9216
    ds_read_b64_tr_b16 v[40:41], v122 offset:8192
    ds_read_b64_tr_b16 v[42:43], v122 offset:9216
    v_cmp_le_i32 vcc, 96, v0
    s_cbranch_vccnz VRD1
WC_22:
    ds_read_b32 v0, v147 offset:28
    s_sub_u32 s56, s56, 1
    s_cbranch_scc1 EXIT
    s_waitcnt lgkmcnt(0)
    v_cmp_le_i32 vcc, 96, v0
    s_cbranch_vccz WC_22
VRD1:
    s_waitcnt lgkmcnt(4)
    ds_read_b64_tr_b16 v[12:13], v165 offset:16384
    ds_read_b64_tr_b16 v[14:15], v165 offset:17408
    ds_read_b64_tr_b16 v[44:45], v122 offset:16384
    ds_read_b64_tr_b16 v[46:47], v122 offset:17408
    ds_read_b64_tr_b16 v[16:17], v165 offset:24576
    ds_read_b64_tr_b16 v[18:19], v165 offset:25600
    ds_read_b64_tr_b16 v[48:49], v122 offset:24576
    ds_read_b64_tr_b16 v[50:51], v122 offset:25600
    v_cmp_le_i32 vcc, 112, v0
    s_cbranch_vccnz VRD2
WC_23:
    ds_read_b32 v0, v147 offset:28
    s_sub_u32 s56, s56, 1
    s_cbranch_scc1 EXIT
    s_waitcnt lgkmcnt(0)
    v_cmp_le_i32 vcc, 112, v0
    s_cbranch_vccz WC_23
VRD2:
    s_waitcnt lgkmcnt(4)
    ds_read_b64_tr_b16 v[20:21], v165 offset:32768
    ds_read_b64_tr_b16 v[22:23], v165 offset:33792
    ds_read_b64_tr_b16 v[52:53], v122 offset:32768
    ds_read_b64_tr_b16 v[54:55], v122 offset:33792
    ds_read_b64_tr_b16 v[24:25], v165 offset:40960
    ds_read_b64_tr_b16 v[26:27], v165 offset:41984
    ds_read_b64_tr_b16 v[56:57], v122 offset:40960
    ds_read_b64_tr_b16 v[58:59], v122 offset:41984
    v_cmp_le_i32 vcc, 128, v0
    s_cbranch_vccnz VRD3
WC_24:
    ds_read_b32 v0, v147 offset:28
    s_sub_u32 s56, s56, 1
    s_cbranch_scc1 EXIT
    s_waitcnt lgkmcnt(0)
    v_cmp_le_i32 vcc, 128, v0
    s_cbranch_vccz WC_24
VRD3:
    s_waitcnt lgkmcnt(4)
    ds_read_b64_tr_b16 v[28:29], v165 offset:49152
    ds_read_b64_tr_b16 v[30:31], v165 offset:50176
    ds_read_b64_tr_b16 v[60:61], v122 offset:49152
    ds_read_b64_tr_b16 v[62:63], v122 offset:50176
    ds_read_b64_tr_b16 v[32:33], v165 offset:57344
    ds_read_b64_tr_b16 v[34:35], v165 offset:58368
    ds_read_b64_tr_b16 v[64:65], v122 offset:57344
    ds_read_b64_tr_b16 v[66:67], v122 offset:58368
    s_waitcnt lgkmcnt(0)
    s_mov_b64 exec, 1
    ds_add_u32 v147, v162 offset:36
    s_mov_b64 exec, -1
    s_branch P0_20b
PO_25:
    buffer_store_dword v104, v151, s[40:43], s57 offen sc1
    s_mov_b32 exec_lo, 1
    s_mov_b32 exec_hi, 2
    buffer_store_dwordx2 v[120:121], v152, s[40:43], s57 offen sc1
    s_branch PO_25b
P0_27:
    s_add_u32 s67, s62, 128
WC_28:
    ds_read_b32 v0, v147 offset:28
    s_sub_u32 s56, s56, 1
    s_cbranch_scc1 EXIT
    s_waitcnt lgkmcnt(0)
    v_cmp_le_i32 vcc, s67, v0
    s_cbranch_vccz WC_28
    ds_read_b64_tr_b16 v[68:69], v142 offset:24576
    ds_read_b64_tr_b16 v[70:71], v142 offset:25088
    ds_read_b64_tr_b16 v[72:73], v142 offset:28672
    ds_read_b64_tr_b16 v[74:75], v142 offset:29184
    ds_read_b64_tr_b16 v[76:77], v142 offset:32768
    ds_read_b64_tr_b16 v[78:79], v142 offset:33280
    ds_read_b64_tr_b16 v[80:81], v142 offset:36864
    ds_read_b64_tr_b16 v[82:83], v142 offset:37376
    ds_read_b64_tr_b16 v[84:85], v142 offset:40960
    ds_read_b64_tr_b16 v[86:87], v142 offset:41472
    ds_read_b64_tr_b16 v[88:89], v142 offset:45056
    ds_read_b64_tr_b16 v[90:91], v142 offset:45568
WC_29:
    ds_read_b32 v0, v147 offset:24
    s_sub_u32 s56, s56, 1
    s_cbranch_scc1 EXIT
    s_waitcnt lgkmcnt(0)
    v_cmp_le_i32 vcc, 1, v0
    s_cbranch_vccz WC_29
    s_mov_b64 exec, 1
    ds_add_u32 v147, v162 offset:16
    s_mov_b64 exec, -1
WC_30:
    ds_read_b32 v0, v147 offset:16
    s_sub_u32 s56, s56, 1
    s_cbranch_scc1 EXIT
    s_waitcnt lgkmcnt(0)
    v_cmp_le_i32 vcc, 8, v0
    s_cbranch_vccz WC_30
    s_branch P0_27b
P0_31:
    s_mov_b64 exec, 1
    ds_add_u32 v147, v162 offset:16
    s_mov_b64 exec, -1
    s_branch P0_31b
ATTD:
    s_cmp_lt_u32 s50, 27
    s_cbranch_scc0 NEXT
    s_cmp_eq_u32 s54, 0
    s_cbranch_scc1 P0_31
    s_waitcnt lgkmcnt(0)
    s_barrier
P0_31b:
    s_cmp_eq_u32 s48, 7
    s_cbranch_scc0 UW
    s_mov_b64 exec, 0xffff
MO:
    ds_read_b64 v[120:121], v164 offset:4608
    s_sub_u32 s56, s56, 1
    s_cbranch_scc1 EXIT
    s_waitcnt lgkmcnt(0)
    v_max_u32 v122, v120, v121
    v_cmp_eq_u32 vcc, -1, v122
    s_cbranch_vccnz MO
    buffer_store_dwordx2 v[120:121], v150, s[40:43], s58 offen sc1
    v_mov_b64 v[122:123], -1
    ds_write_b64 v164, v[122:123] offset:4608
    s_mov_b64 exec, -1
UW:
    s_cmp_eq_u32 s54, 0
    s_cbranch_scc0 G1DONE
    s_add_u32 s67, s62, 176
WC_32:
    ds_read_b32 v0, v147 offset:28
    s_sub_u32 s56, s56, 1
    s_cbranch_scc1 EXIT
    s_waitcnt lgkmcnt(0)
    v_cmp_le_i32 vcc, s67, v0
    s_cbranch_vccz WC_32
    ds_read_b64_tr_b16 v[68:69], v143 offset:0
    ds_read_b64_tr_b16 v[70:71], v143 offset:512
    ds_read_b64_tr_b16 v[72:73], v143 offset:4096
    ds_read_b64_tr_b16 v[74:75], v143 offset:4608
    ds_read_b64_tr_b16 v[76:77], v143 offset:8192
    ds_read_b64_tr_b16 v[78:79], v143 offset:8704
    ds_read_b64_tr_b16 v[80:81], v143 offset:12288
    ds_read_b64_tr_b16 v[82:83], v143 offset:12800
    ds_read_b64_tr_b16 v[84:85], v143 offset:16384
    ds_read_b64_tr_b16 v[86:87], v143 offset:16896
    ds_read_b64_tr_b16 v[88:89], v143 offset:20480
    ds_read_b64_tr_b16 v[90:91], v143 offset:20992
    s_branch G1DONE
P0_33:
    s_sleep 12
    s_add_u32 s67, s62, 160
WC_34:
    ds_read_b32 v0, v147 offset:28
    s_sub_u32 s56, s56, 1
    s_cbranch_scc1 EXIT
    s_waitcnt lgkmcnt(0)
    v_cmp_le_i32 vcc, s67, v0
    s_cbranch_vccz WC_34
    s_add_u32 s67, s67, 16
    s_cmp_lt_u32 s48, 3
    s_cbranch_scc0 GW3
    buffer_load_dwordx4 v[92:95], v157, s[40:43], s58 offen offset:0 sc1
    buffer_load_dwordx4 v[96:99], v157, s[40:43], s58 offen offset:1152 sc1
    buffer_load_dwordx4 v[100:103], v157, s[40:43], s58 offen offset:2304 sc1
GW3:
WC_35:
    ds_read_b32 v0, v147 offset:28
    s_sub_u32 s56, s56, 1
    s_cbranch_scc1 EXIT
    s_waitcnt lgkmcnt(0)
    v_cmp_le_i32 vcc, s67, v0
    s_cbranch_vccz WC_35
    ds_read_b64_tr_b16 v[68:69], v143 offset:0
    ds_read_b64_tr_b16 v[70:71], v143 offset:512
    ds_read_b64_tr_b16 v[72:73], v143 offset:4096
    ds_read_b64_tr_b16 v[74:75], v143 offset:4608
    ds_read_b64_tr_b16 v[76:77], v143 offset:8192
    ds_read_b64_tr_b16 v[78:79], v143 offset:8704
    ds_read_b64_tr_b16 v[80:81], v143 offset:12288
    ds_read_b64_tr_b16 v[82:83], v143 offset:12800
    ds_read_b64_tr_b16 v[84:85], v143 offset:16384
    ds_read_b64_tr_b16 v[86:87], v143 offset:16896
    ds_read_b64_tr_b16 v[88:89], v143 offset:20480
    ds_read_b64_tr_b16 v[90:91], v143 offset:20992
    s_cmp_lt_u32 s48, 3
    s_cbranch_scc0 G1DONE
    s_branch G1_w
P0_36:
    s_mov_b64 exec, 1
    ds_add_u32 v147, v162 offset:40
    s_mov_b64 exec, -1
WC_37:
    ds_read_b32 v0, v147 offset:40
    s_sub_u32 s56, s56, 1
    s_cbranch_scc1 EXIT
    s_waitcnt lgkmcnt(0)
    v_cmp_le_i32 vcc, 8, v0
    s_cbranch_vccz WC_37
    s_branch P0_36b
PS_38:
    buffer_store_dword v126, v153, s[40:43], s73 offen sc1
    s_branch PS_38b
GST:
    s_mov_b32 exec_hi, 0xffff
    ds_read_b64 v[124:125], v164 offset:128
    s_mov_b32 exec_hi, -1
    v_mov_b64 v[126:127], 0
    s_waitcnt lgkmcnt(0)
    v_dot2c_f32_bf16 v126, s61, v124
    v_dot2c_f32_bf16 v127, v124, v124
    v_dot2c_f32_bf16 v126, s61, v125
    v_dot2c_f32_bf16 v127, v125, v125
    s_nop 2
    v_permlane32_swap_b32 v126, v127
    v_add_f32 v126, v126, v127
    v_mov_b32 v127, v126
    s_nop 1
    v_permlane16_swap_b32 v126, v127
    v_add_f32 v126, v126, v127
    s_nop 1
    v_add_f32_dpp v126, v126, v126 row_ror:8 row_mask:0xf bank_mask:0xf
    s_nop 1
    v_add_f32_dpp v126, v126, v126 row_ror:4 row_mask:0xf bank_mask:0xf
    s_nop 1
    v_add_f32_dpp v126, v126, v126 row_ror:2 row_mask:0xf bank_mask:0xf
    s_nop 1
    v_add_f32_dpp v126, v126, v126 row_ror:1 row_mask:0xf bank_mask:0xf
    s_mov_b32 exec_lo, 0x10001
    s_mov_b32 exec_hi, 0x10001
    s_cmp_eq_u32 s55, 2
    s_cbranch_scc0 PS_38
    buffer_store_dword v126, v153, s[40:43], s73 offen
PS_38b:
    s_mov_b64 exec, -1
    s_branch GNST
PS_39:
    buffer_store_dword v120, v149, s[40:43], s57 offen sc1
    s_branch PS_39b
P0_40:
    s_cmp_lt_u32 s48, 3
    s_cbranch_scc0 H5DONE
    v_mov_b64 v[104:105], 0
    v_mov_b64 v[106:107], 0
    v_mov_b64 v[108:109], 0
    v_mov_b64 v[110:111], 0
    v_mov_b64 v[112:113], 0
    v_mov_b64 v[114:115], 0
H5S:
    s_mov_b32 exec_lo, 0xffffffff
    s_mov_b32 exec_hi, 0x0
    buffer_load_dwordx4 v[104:107], v158, s[40:43], s66 offen offset:0 sc1
    buffer_load_dwordx4 v[108:111], v158, s[40:43], s66 offen offset:640 sc1
    buffer_load_dwordx4 v[112:115], v158, s[40:43], s66 offen offset:1280 sc1
    s_mov_b64 exec, -1
    buffer_load_dwordx4 v[92:95], v158, s[40:43], s57 offen offset:0 sc1
    buffer_load_dwordx4 v[96:99], v158, s[40:43], s57 offen offset:640 sc1
    buffer_load_dwordx4 v[100:103], v158, s[40:43], s57 offen offset:1280 sc1
    s_sub_u32 s56, s56, 1
    s_cbranch_scc1 EXIT
    s_waitcnt vmcnt(0)
    v_max3_u32 v124, v92, v93, v94
    v_max3_u32 v124, v124, v95, v96
    v_max3_u32 v124, v124, v97, v98
    v_max3_u32 v124, v124, v99, v100
    v_max3_u32 v124, v124, v101, v102
    v_max_u32 v124, v124, v103
    v_max3_u32 v125, v104, v105, v106
    v_max3_u32 v125, v125, v107, v108
    v_max3_u32 v125, v125, v109, v110
    v_max3_u32 v125, v125, v111, v112
    v_max3_u32 v125, v125, v113, v114
    v_max_u32 v125, v125, v115
    v_pk_add_f32 v[120:121], v[92:93], v[96:97]
    v_pk_add_f32 v[122:123], v[94:95], v[98:99]
    v_max_u32 v124, v124, v125
    v_cmp_eq_u32 vcc, -1, v124
    v_pk_add_f32 v[120:121], v[120:121], v[100:101]
    v_pk_add_f32 v[122:123], v[122:123], v[102:103]
    s_cbranch_vccnz H5S
    v_add_f32 v136, v104, v108
    v_add_f32 v136, v136, v112
    v_mul_f32 v136, 0xbae38e39, v136
    v_add_f32 v137, v105, v109
    v_add_f32 v137, v137, v113
    v_mul_f32 v137, 0xbae38e39, v137
    v_add_f32 v138, v106, v110
    v_add_f32 v138, v138, v114
    v_mul_f32 v138, 0xbae38e39, v138
    v_add_f32 v139, v107, v111
    v_add_f32 v139, v139, v115
    v_mul_f32 v139, 0xbae38e39, v139
    s_branch H5C
P0_41:
    ds_read_b64_tr_b16 v[68:69], v165 offset:0
    ds_read_b64_tr_b16 v[70:71], v165 offset:512
    ds_read_b64_tr_b16 v[72:73], v165 offset:4096
    ds_read_b64_tr_b16 v[74:75], v165 offset:4608
    ds_read_b64_tr_b16 v[76:77], v165 offset:8192
    ds_read_b64_tr_b16 v[78:79], v165 offset:8704
    ds_read_b64_tr_b16 v[80:81], v165 offset:12288
    ds_read_b64_tr_b16 v[82:83], v165 offset:12800
    ds_read_b64_tr_b16 v[84:85], v165 offset:16384
    ds_read_b64_tr_b16 v[86:87], v165 offset:16896
    ds_read_b64_tr_b16 v[88:89], v165 offset:20480
    ds_read_b64_tr_b16 v[90:91], v165 offset:20992
    s_waitcnt lgkmcnt(0)
    s_branch P0_41b
DNOM:
    s_barrier
    s_cmp_eq_u32 s48, 7
    s_cbranch_scc0 NEXT
    s_mov_b64 exec, 0xffff
MD:
    ds_read_b64 v[120:121], v164 offset:4608
    s_sub_u32 s56, s56, 1
    s_cbranch_scc1 EXIT
    s_waitcnt lgkmcnt(0)
    v_max_u32 v122, v120, v121
    v_cmp_eq_u32 vcc, -1, v122
    s_cbranch_vccnz MD
    buffer_store_dwordx2 v[120:121], v150, s[40:43], s74 offen sc1
    v_mov_b64 v[122:123], -1
    ds_write_b64 v164, v[122:123] offset:4608
    s_mov_b64 exec, -1
    s_branch NEXT
P0_42:
    ds_read_b64_tr_b16 v[68:69], v142 offset:0
    ds_read_b64_tr_b16 v[70:71], v142 offset:512
    ds_read_b64_tr_b16 v[72:73], v142 offset:4096
    ds_read_b64_tr_b16 v[74:75], v142 offset:4608
    ds_read_b64_tr_b16 v[76:77], v142 offset:8192
    ds_read_b64_tr_b16 v[78:79], v142 offset:8704
    ds_read_b64_tr_b16 v[80:81], v142 offset:12288
    ds_read_b64_tr_b16 v[82:83], v142 offset:12800
    ds_read_b64_tr_b16 v[84:85], v142 offset:16384
    ds_read_b64_tr_b16 v[86:87], v142 offset:16896
    ds_read_b64_tr_b16 v[88:89], v142 offset:20480
    ds_read_b64_tr_b16 v[90:91], v142 offset:20992
    s_cmp_lt_u32 s48, 3
    s_cbranch_scc0 NEXT
    s_sleep 15
    s_branch G2
EXIT:
EXIT0:
    s_endpgm

.section .rodata,"a"
.p2align 6
.amdhsa_kernel interleave_layers__sliding_block_cached__glu_gated_bilinear__decode_kernel
  .amdhsa_next_free_vgpr 168
  .amdhsa_next_free_sgpr 96
  .amdhsa_accum_offset 168
  .amdhsa_group_segment_fixed_size 0
  .amdhsa_kernarg_size 96
  .amdhsa_user_sgpr_count 2
  .amdhsa_user_sgpr_kernarg_segment_ptr 1
  .amdhsa_system_sgpr_workgroup_id_x 1
  .amdhsa_float_denorm_mode_32 3
.end_amdhsa_kernel
```
